```python
import torch

def _softmax(x, axis=-1):
    return torch.softmax(x, dim=axis)
def _gelu(x):
    return torch.nn.functional.gelu(x, approximate="tanh")
def _silu(x):
    return torch.nn.functional.silu(x)
def _sigmoid(x):
    return torch.sigmoid(x)
def _layernorm(x, axis=-1, eps=1e-5):
    m = x.mean(dim=axis, keepdim=True)
    v = x.var(dim=axis, keepdim=True, unbiased=False)
    return (x - m) / torch.sqrt(v + eps)
def _scatter_add(tgt, idx, src, axis=0):
    return tgt.clone().index_add_(axis, idx, src)
def _segment_sum(src, seg, n):
    out = torch.zeros((n,) + src.shape[1:], dtype=src.dtype)
    return out.index_add_(0, seg, src)
def _pad(x, pw):
    flat = tuple(v for pair in reversed(pw) for v in pair)
    return torch.nn.functional.pad(x, flat)

kernel_name = 'standalone__cross_network_dcn__recsys'

def setup_inputs():

    _w = (lambda a: (lambda t: t.to(torch.bfloat16) if t.is_floating_point() else t)(torch.as_tensor(a)))
    B, F, D, L = 4096, 26, 32, 3
    Din = min(F * D, 1024)
    return {
        "x0": _w((lambda *s: torch.randn(*s, dtype=torch.bfloat16) * 0.05)(B, Din)),
        "ws": _w((lambda *s: torch.randn(*s, dtype=torch.bfloat16) * 0.8)(L, Din, Din) * (Din ** -0.5)),
        "bs": _w((lambda *s: torch.randn(*s, dtype=torch.bfloat16) * 3.2)(L, Din) * 0.01),
    }

def reference(x0, ws, bs):
    x = x0
    L = ws.shape[0]
    for l in range(L):
        proj = torch.einsum('bd,de->be', x, ws[l]) + bs[l]
        x = x0 * proj + x
    return x
```

```asm
; @launch grid=(256,1,1) block=(256,1,1) lds=163840
.amdgcn_target "amdgcn-amd-amdhsa--gfx950"
.text
.globl standalone__cross_network_dcn__recsys_kernel
.p2align 8
.type standalone__cross_network_dcn__recsys_kernel,@function
standalone__cross_network_dcn__recsys_kernel:
s_load_dwordx8 s[4:11], s[0:1], 0
s_load_dwordx2 s[14:15], s[0:1], 40
s_cmp_ge_u32 s2, 256
s_cbranch_scc1 L_end
v_lshrrev_b32 v2, 6, v0
v_and_b32 v1, 63, v0
s_and_b32 s44, s2, 7
v_readfirstlane_b32 s38, v2
s_lshr_b32 s39, s2, 6
s_bfe_u32 s36, s2, 0x30003
s_lshl_b32 s37, s39, 3
s_add_u32 s37, s37, s44
s_lshl_b32 s93, s44, 1
s_lshl_b32 s80, s36, 8
s_sub_u32 s45, s44, 6
s_min_u32 s93, s44, s45
s_mov_b32 s18, 4153344
s_mov_b32 s19, 0x20000
s_mov_b32 s22, 6815744
s_mov_b32 s23, 0x20000
s_cmp_eq_u32 s36, 7
s_cbranch_scc1 L_helper
s_lshl_b32 s43, s37, 2
s_add_u32 s43, s43, s38
s_mul_i32 s46, s43, 53248
v_lshrrev_b32 v2, 3, v1
v_and_b32 v3, 7, v1
v_lshrrev_b32 v4, 4, v1
v_mul_u32_u24 v6, 1664, v2
v_add_u32 v6, s46, v6
v_xor_b32 v7, v4, v3
v_lshl_add_u32 v12, v7, 4, v6
v_xor_b32 v7, 4, v7
v_lshl_add_u32 v13, v7, 4, v6
v_add_u32 v13, 12288, v13
v_add_u32 v14, 24576, v12
v_add_u32 v15, 24576, v13
s_mul_i32 s47, s38, 12288
s_add_u32 s47, s47, 110592
s_lshl_b32 s44, s36, 8
s_lshl_b32 s41, s38, 10
v_and_b32 v5, 1, v4
v_lshlrev_b32 v5, 2, v5
v_xor_b32 v5, v5, v3
v_lshl_add_u32 v5, v5, 4, s44
s_lshr_b32 s42, s38, 1
s_lshl_b32 s42, s42, 4
s_and_b32 s40, s38, 1
s_lshl_b32 s48, s40, 2
s_add_u32 s42, s42, s48
v_lshrrev_b32 v7, 5, v1
v_and_b32 v6, 3, v2
v_lshl_add_u32 v6, v7, 3, v6
v_add_u32 v6, s42, v6
v_mul_u32_u24 v6, 1664, v6
v_add_u32 v8, v5, v6
v_add_u32 v9, 128, v8
v_add_u32 v10, 53248, v8
v_add_u32 v11, 53376, v8
v_mul_i32_i24 v223, 0xffffe600, v7
s_mul_i32 s40, s40, 6656
v_add_u32 v223, s40, v223
s_mul_i32 s42, s80, 832
s_mov_b32 m0, s41
s_min_u32 s45, s38, 2
s_mul_i32 s40, s45, 1664
s_add_u32 s40, s40, s44
v_lshlrev_b32 v6, 2, v1
s_mov_b32 s34, 4992
s_mov_b32 s35, 0x20000
s_waitcnt lgkmcnt(0)
s_mov_b32 s16, s6
s_mov_b32 s17, s7
s_mov_b32 s20, s4
s_mov_b32 s21, s5
buffer_load_dwordx4 v8, s[16:19], s42 offen lds
s_mov_b32 m0, s47
s_mov_b32 s32, s8
s_mov_b32 s33, s9
buffer_load_dwordx4 v12, s[20:23], s80 offen offset:0 lds
buffer_load_dwordx4 v13, s[20:23], s80 offen offset:1024 lds
buffer_load_dwordx4 v14, s[20:23], s80 offen offset:2048 lds
buffer_load_dword v192, v6, s[32:35], s40 offen
s_mov_b32 s24, s14
s_mov_b32 s25, s15
s_mov_b32 s26, 33554432
s_mov_b32 s27, 0x20000
s_mov_b32 s28, s10
s_mov_b32 s29, s11
s_mov_b32 s30, 6815744
s_mov_b32 s31, 0x20000
s_lshl_b32 s40, s43, 7
s_add_u32 s40, s40, 8388608
v_min_u32 v5, 5, v1
v_lshl_add_u32 v5, v5, 14, s40
buffer_load_dwordx2 v[216:217], v5, s[24:27], 0 offen sc1
s_add_u32 s76, s14, 16777216
s_addc_u32 s77, s15, 0
s_mov_b32 s78, 8388608
s_mov_b32 s79, 0x20000
s_mov_b32 s48, 0x7a432510
s_mov_b32 s49, 0xcb986
s_cmp_eq_u32 s39, 1
s_cselect_b32 s48, 0x75436120, s48
s_cselect_b32 s49, 0xca98b, s49
s_cmp_eq_u32 s39, 2
s_cselect_b32 s48, 0x75482130, s48
s_cselect_b32 s49, 0xba9c6, s49
s_cmp_eq_u32 s39, 3
s_cselect_b32 s48, 0x75932140, s48
s_cselect_b32 s49, 0xcba86, s49
v_lshlrev_b32 v208, 2, v1
v_lshrrev_b64 v[208:209], v208, s[48:49]
v_and_b32 v208, 15, v208
v_add3_u32 v209, v208, s93, -1
v_subrev_u32 v210, 6, v209
v_min_u32 v209, v209, v210
v_add3_u32 v209, v209, s36, 1
v_subrev_u32 v210, 7, v209
v_min_u32 v209, v209, v210
v_lshlrev_b32 v209, 1, v209
s_sub_u32 s40, s36, s93
s_add_u32 s48, s40, 6
s_min_u32 s40, s40, s48
s_cmp_eq_u32 s36, 6
s_cselect_b32 s40, 5, s40
s_cselect_b32 s32, 0, s36
v_subrev_u32 v210, 8, v208
v_cmp_le_i32 vcc, s40, v210
v_mov_b32 v211, s40
s_nop 0
v_addc_co_u32 v210, vcc, 0, v210, vcc
v_cmp_eq_u32 vcc, 7, v208
s_nop 1
v_cndmask_b32 v210, v210, v211, vcc
v_add_u32 v210, s93, v210
v_subrev_u32 v211, 6, v210
v_min_u32 v210, v210, v211
v_lshl_or_b32 v210, v210, 1, 1
v_cmp_gt_u32 vcc, 7, v208
s_nop 1
v_cndmask_b32 v208, v210, v209, vcc
v_lshlrev_b32 v208, 7, v208
v_mul_u32_u24 v209, 832, v208
s_nop 0
s_mov_b32 s3, s42
v_readlane_b32 s4, v209, 1
v_readlane_b32 s5, v209, 2
v_readlane_b32 s6, v209, 3
v_readlane_b32 s7, v209, 4
v_readlane_b32 s8, v209, 5
v_readlane_b32 s9, v209, 6
v_readlane_b32 s10, v209, 7
v_readlane_b32 s11, v209, 8
v_readlane_b32 s12, v209, 9
v_readlane_b32 s13, v209, 10
v_readlane_b32 s14, v209, 11
v_readlane_b32 s15, v209, 12
v_readlane_b32 s81, v208, 1
v_readlane_b32 s82, v208, 2
v_readlane_b32 s83, v208, 3
v_readlane_b32 s84, v208, 4
v_readlane_b32 s85, v208, 5
v_readlane_b32 s86, v208, 6
v_readlane_b32 s87, v208, 7
v_readlane_b32 s88, v208, 8
v_readlane_b32 s89, v208, 9
v_readlane_b32 s90, v208, 10
v_readlane_b32 s91, v208, 11
v_readlane_b32 s92, v208, 12
buffer_load_dwordx4 v15, s[20:23], s80 offen offset:3072 lds
s_add_u32 m0, s41, 4096
s_nop 0
buffer_load_dwordx4 v10, s[16:19], s42 offen lds
s_lshl_b32 s45, s45, 9
s_add_u32 s45, s45, 159744
v_lshl_add_u32 v196, v1, 3, s45
s_mov_b32 s34, s44
s_lshl_b32 s44, s43, 7
s_add_u32 s44, s44, 8388608
v_lshl_add_u32 v30, v3, 3, s44
v_lshlrev_b32 v29, 4, v7
v_add_u32 v29, 159744, v29
s_lshl_b32 s45, s36, 3
s_add_u32 s45, s45, s44
v_mov_b32 v5, 0x80000000
v_mov_b32 v6, s45
v_cmp_eq_u32 vcc, 0, v1
s_nop 0
v_and_b32 v2, 31, v1
v_cndmask_b32 v31, v5, v6, vcc
s_add_u32 s42, s42, 128
s_cmp_eq_u32 s36, 6
s_cselect_b32 s42, s4, s42
s_add_u32 m0, s41, 8192
s_nop 0
buffer_load_dwordx4 v8, s[16:19], s42 offen lds
s_add_u32 m0, s41, 12288
s_nop 0
buffer_load_dwordx4 v10, s[16:19], s42 offen lds
v_bfe_u32 v27, v1, 1, 3
v_lshl_add_u32 v2, v2, 7, s47
v_add_u32 v6, 0, v7
v_xor_b32 v6, v6, v27
v_lshl_add_u32 v16, v6, 4, v2
v_add_u32 v6, 2, v7
v_xor_b32 v6, v6, v27
v_lshl_add_u32 v17, v6, 4, v2
v_add_u32 v6, 4, v7
v_xor_b32 v6, v6, v27
v_lshl_add_u32 v18, v6, 4, v2
v_add_u32 v6, 6, v7
v_xor_b32 v6, v6, v27
v_lshl_add_u32 v19, v6, 4, v2
v_lshl_add_u32 v28, v7, 3, v2
s_add_u32 m0, s47, 4096
v_bfe_u32 v3, v1, 2, 2
buffer_load_dwordx4 v12, s[20:23], s81 offen offset:0 lds
buffer_load_dwordx4 v13, s[20:23], s81 offen offset:1024 lds
v_lshl_add_u32 v4, v7, 2, v3
v_lshlrev_b32 v4, 7, v4
v_bfe_u32 v6, v1, 4, 1
v_lshl_add_u32 v4, v6, 5, v4
v_and_b32 v6, 3, v1
v_lshl_add_u32 v4, v6, 3, v4
v_lshrrev_b32 v3, 1, v3
buffer_load_dwordx4 v14, s[20:23], s81 offen offset:2048 lds
buffer_load_dwordx4 v15, s[20:23], s81 offen offset:3072 lds
v_xor_b32 v6, 0, v3
v_lshl_add_u32 v20, v6, 6, v4
v_xor_b32 v6, 1, v3
v_lshl_add_u32 v21, v6, 6, v4
s_cmp_eq_u32 s38, 0
s_cselect_b32 s45, 1.0, 0
s_getreg_b32 s33, hwreg(HW_REG_XCC_ID, 0, 4)
s_mov_b32 s35, s46
s_mov_b32 s46, 0x40000
s_cmp_eq_u32 s36, 6
s_cbranch_scc1 L_m6
L_mr:
s_waitcnt vmcnt(9)
v_lshlrev_b32 v194, 16, v192
v_and_b32 v195, 0xffff0000, v192
v_add_f32 v194, s45, v194
v_add_f32 v195, s45, v195
ds_write_b64 v196, v[194:195]
s_add_u32 m0, s41, 16384
s_nop 0
buffer_load_dwordx4 v8, s[16:19], s4 offen lds
s_add_u32 m0, s41, 20480
s_nop 0
buffer_load_dwordx4 v10, s[16:19], s4 offen lds
s_add_u32 m0, s41, 24576
s_nop 0
buffer_load_dwordx4 v9, s[16:19], s4 offen lds
s_add_u32 m0, s41, 28672
s_nop 0
buffer_load_dwordx4 v11, s[16:19], s4 offen lds
v_add_u32 v210, s36, v1
v_subrev_u32 v211, 7, v210
v_min_u32 v210, v210, v211
v_lshlrev_b32 v210, 1, v210
v_add3_u32 v211, v1, s32, -7
v_subrev_u32 v212, 6, v211
v_min_u32 v211, v211, v212
v_lshl_or_b32 v211, v211, 1, 1
v_cmp_gt_u32 vcc, 7, v1
s_nop 1
v_cndmask_b32 v210, v211, v210, vcc
v_mul_u32_u24 v212, 106496, v210
v_lshlrev_b32 v213, 12, v210
v_lshl_add_u32 v26, v1, 4, s35
v_add_u32 v22, 0x10000, v20
v_add_u32 v23, 0x10000, v21
v_add_u32 v24, 0x20000, v20
v_add_u32 v25, 0x20000, v21
v_readlane_b32 s50, v212, 0
v_readlane_b32 s51, v212, 1
v_readlane_b32 s52, v212, 2
v_readlane_b32 s53, v212, 3
v_readlane_b32 s54, v212, 4
v_readlane_b32 s55, v212, 5
v_readlane_b32 s56, v212, 6
v_readlane_b32 s57, v212, 7
v_readlane_b32 s58, v212, 8
v_readlane_b32 s59, v212, 9
v_readlane_b32 s60, v212, 10
v_readlane_b32 s61, v212, 11
v_readlane_b32 s62, v212, 12
v_readlane_b32 s63, v213, 0
v_readlane_b32 s64, v213, 1
v_readlane_b32 s65, v213, 2
v_readlane_b32 s66, v213, 3
v_readlane_b32 s67, v213, 4
v_readlane_b32 s68, v213, 5
v_readlane_b32 s69, v213, 6
v_readlane_b32 s70, v213, 7
v_readlane_b32 s71, v213, 8
v_readlane_b32 s72, v213, 9
v_readlane_b32 s73, v213, 10
v_readlane_b32 s74, v213, 11
v_readlane_b32 s75, v213, 12
s_waitcnt vmcnt(12)
v_readlane_b32 s48, v216, 3
v_readlane_b32 s49, v217, 3
s_nop 3
s_or_b32 s48, s48, 1
s_add_u32 s48, s48, 2
s_add_u32 s49, s49, 1
s_add_u32 s33, s33, s49
s_add_u32 s33, s33, 16
v_mov_b32 v6, s48
v_mov_b32 v7, s33
s_mov_b32 s44, 65536
buffer_store_dwordx2 v[6:7], v31, s[24:27], s44 offen sc1
s_nop 0
v_mov_b32 v7, s49
s_waitcnt lgkmcnt(0)
s_waitcnt vmcnt(11)
s_barrier
ds_read_b128 v[224:227], v29 offset:0
ds_read_b128 v[228:231], v29 offset:32
ds_read_b128 v[232:235], v29 offset:64
ds_read_b128 v[236:239], v29 offset:96
ds_read_b128 v[240:243], v29 offset:128
ds_read_b128 v[244:247], v29 offset:160
ds_read_b128 v[248:251], v29 offset:192
ds_read_b128 v[252:255], v29 offset:224
ds_read_b64_tr_b16 a[192:193], v20 offset:0
ds_read_b64_tr_b16 a[194:195], v20 offset:1024
ds_read_b64_tr_b16 a[196:197], v21 offset:0
ds_read_b64_tr_b16 a[198:199], v21 offset:1024
ds_read_b64_tr_b16 a[200:201], v20 offset:2048
ds_read_b64_tr_b16 a[202:203], v20 offset:3072
ds_read_b64_tr_b16 a[204:205], v21 offset:2048
ds_read_b64_tr_b16 a[206:207], v21 offset:3072
ds_read_b128 v[160:163], v16 offset:0
ds_read_b128 v[164:167], v17 offset:0
ds_read_b128 v[168:171], v18 offset:0
ds_read_b128 v[172:175], v19 offset:0
s_waitcnt lgkmcnt(2)
v_mfma_f32_32x32x16_bf16 v[32:47], a[192:195], v[160:163], v[224:239]
ds_read_b64_tr_b16 a[208:209], v20 offset:4096
ds_read_b64_tr_b16 a[210:211], v20 offset:5120
ds_read_b64_tr_b16 a[212:213], v21 offset:4096
s_add_u32 m0, s41, 32768
v_mfma_f32_32x32x16_bf16 v[48:63], a[196:199], v[160:163], v[240:255]
buffer_load_dwordx4 v8, s[16:19], s5 offen lds
ds_read_b64_tr_b16 a[214:215], v21 offset:5120
ds_read_b64_tr_b16 a[216:217], v20 offset:6144
ds_read_b64_tr_b16 a[218:219], v20 offset:7168
s_add_u32 m0, s41, 36864
v_mfma_f32_32x32x16_bf16 v[32:47], a[200:203], v[164:167], v[32:47]
buffer_load_dwordx4 v10, s[16:19], s5 offen lds
ds_read_b64_tr_b16 a[220:221], v21 offset:6144
ds_read_b64_tr_b16 a[222:223], v21 offset:7168
s_add_u32 m0, s41, 40960
v_mfma_f32_32x32x16_bf16 v[48:63], a[204:207], v[164:167], v[48:63]
buffer_load_dwordx4 v9, s[16:19], s5 offen lds
ds_read_b128 v[224:227], v29 offset:256
s_waitcnt vmcnt(12) lgkmcnt(1)
v_mfma_f32_32x32x16_bf16 v[32:47], a[208:211], v[168:171], v[32:47]
s_barrier
ds_read_b64_tr_b16 a[192:193], v20 offset:8192
ds_read_b64_tr_b16 a[194:195], v20 offset:9216
s_add_u32 m0, s47, 8192
v_mfma_f32_32x32x16_bf16 v[48:63], a[212:215], v[168:171], v[48:63]
buffer_load_dwordx4 v12, s[20:23], s82 offen offset:0 lds
ds_read_b64_tr_b16 a[196:197], v21 offset:8192
ds_read_b64_tr_b16 a[198:199], v21 offset:9216
ds_read_b64_tr_b16 a[200:201], v20 offset:10240
v_mfma_f32_32x32x16_bf16 v[32:47], a[216:219], v[172:175], v[32:47]
buffer_load_dwordx4 v13, s[20:23], s82 offen offset:1024 lds
ds_read_b64_tr_b16 a[202:203], v20 offset:11264
ds_read_b64_tr_b16 a[204:205], v21 offset:10240
ds_read_b64_tr_b16 a[206:207], v21 offset:11264
v_mfma_f32_32x32x16_bf16 v[48:63], a[220:223], v[172:175], v[48:63]
buffer_load_dwordx4 v14, s[20:23], s82 offen offset:2048 lds
ds_read_b128 v[228:231], v29 offset:288
ds_read_b128 v[232:235], v29 offset:320
ds_read_b128 v[236:239], v29 offset:352
ds_read_b128 v[240:243], v29 offset:384
ds_read_b128 v[244:247], v29 offset:416
ds_read_b128 v[248:251], v29 offset:448
ds_read_b128 v[252:255], v29 offset:480
s_waitcnt lgkmcnt(0)
v_mfma_f32_32x32x16_bf16 v[64:79], a[192:195], v[160:163], v[224:239]
ds_read_b64_tr_b16 a[208:209], v20 offset:12288
ds_read_b64_tr_b16 a[210:211], v20 offset:13312
ds_read_b64_tr_b16 a[212:213], v21 offset:12288
s_waitcnt vmcnt(11)
ds_read_b128 a[0:3], v16 offset:4096
v_mfma_f32_32x32x16_bf16 v[80:95], a[196:199], v[160:163], v[240:255]
buffer_load_dwordx4 v15, s[20:23], s82 offen offset:3072 lds
ds_read_b64_tr_b16 a[214:215], v21 offset:13312
ds_read_b64_tr_b16 a[216:217], v20 offset:14336
ds_read_b64_tr_b16 a[218:219], v20 offset:15360
s_add_u32 m0, s41, 45056
v_mfma_f32_32x32x16_bf16 v[64:79], a[200:203], v[164:167], v[64:79]
buffer_load_dwordx4 v11, s[16:19], s5 offen lds
ds_read_b64_tr_b16 a[220:221], v21 offset:14336
ds_read_b64_tr_b16 a[222:223], v21 offset:15360
s_add_u32 m0, s41, 49152
v_mfma_f32_32x32x16_bf16 v[80:95], a[204:207], v[164:167], v[80:95]
buffer_load_dwordx4 v8, s[16:19], s6 offen lds
ds_read_b128 a[4:7], v17 offset:4096
s_waitcnt vmcnt(12) lgkmcnt(1)
v_mfma_f32_32x32x16_bf16 v[64:79], a[208:211], v[168:171], v[64:79]
s_barrier
ds_read_b64_tr_b16 a[192:193], v20 offset:16384
ds_read_b64_tr_b16 a[194:195], v20 offset:17408
s_add_u32 m0, s41, 53248
v_mfma_f32_32x32x16_bf16 v[80:95], a[212:215], v[168:171], v[80:95]
buffer_load_dwordx4 v10, s[16:19], s6 offen lds
ds_read_b64_tr_b16 a[196:197], v21 offset:16384
ds_read_b64_tr_b16 a[198:199], v21 offset:17408
ds_read_b64_tr_b16 a[200:201], v20 offset:18432
s_add_u32 m0, s41, 57344
v_mfma_f32_32x32x16_bf16 v[64:79], a[216:219], v[172:175], v[64:79]
buffer_load_dwordx4 v9, s[16:19], s6 offen lds
ds_read_b64_tr_b16 a[202:203], v20 offset:19456
ds_read_b64_tr_b16 a[204:205], v21 offset:18432
ds_read_b64_tr_b16 a[206:207], v21 offset:19456
s_add_u32 m0, s47, 0
v_mfma_f32_32x32x16_bf16 v[80:95], a[220:223], v[172:175], v[80:95]
buffer_load_dwordx4 v12, s[20:23], s83 offen offset:0 lds
ds_read_b128 a[8:11], v18 offset:4096
ds_read_b128 a[12:15], v19 offset:4096
s_waitcnt lgkmcnt(2)
v_mfma_f32_32x32x16_bf16 v[32:47], a[192:195], a[0:3], v[32:47]
ds_read_b64_tr_b16 a[208:209], v20 offset:20480
ds_read_b64_tr_b16 a[210:211], v20 offset:21504
ds_read_b64_tr_b16 a[212:213], v21 offset:20480
v_permlane32_swap_b32 v160, v162
v_mfma_f32_32x32x16_bf16 v[48:63], a[196:199], a[0:3], v[48:63]
buffer_load_dwordx4 v13, s[20:23], s83 offen offset:1024 lds
ds_read_b64_tr_b16 a[214:215], v21 offset:21504
ds_read_b64_tr_b16 a[216:217], v20 offset:22528
ds_read_b64_tr_b16 a[218:219], v20 offset:23552
v_mfma_f32_32x32x16_bf16 v[32:47], a[200:203], a[4:7], v[32:47]
buffer_load_dwordx4 v14, s[20:23], s83 offen offset:2048 lds
ds_read_b64_tr_b16 a[220:221], v21 offset:22528
ds_read_b64_tr_b16 a[222:223], v21 offset:23552
v_mfma_f32_32x32x16_bf16 v[48:63], a[204:207], a[4:7], v[48:63]
buffer_load_dwordx4 v15, s[20:23], s83 offen offset:3072 lds
s_waitcnt vmcnt(7) lgkmcnt(0)
v_mfma_f32_32x32x16_bf16 v[32:47], a[208:211], a[8:11], v[32:47]
s_barrier
ds_read_b64_tr_b16 a[192:193], v20 offset:24576
ds_read_b64_tr_b16 a[194:195], v20 offset:25600
s_add_u32 m0, s41, 61440
v_mfma_f32_32x32x16_bf16 v[48:63], a[212:215], a[8:11], v[48:63]
buffer_load_dwordx4 v11, s[16:19], s6 offen lds
ds_read_b64_tr_b16 a[196:197], v21 offset:24576
ds_read_b64_tr_b16 a[198:199], v21 offset:25600
ds_read_b64_tr_b16 a[200:201], v20 offset:26624
s_add_u32 m0, s41, 65536
v_mfma_f32_32x32x16_bf16 v[32:47], a[216:219], a[12:15], v[32:47]
buffer_load_dwordx4 v8, s[16:19], s7 offen lds
ds_read_b64_tr_b16 a[202:203], v20 offset:27648
ds_read_b64_tr_b16 a[204:205], v21 offset:26624
ds_read_b64_tr_b16 a[206:207], v21 offset:27648
s_add_u32 m0, s41, 69632
v_mfma_f32_32x32x16_bf16 v[48:63], a[220:223], a[12:15], v[48:63]
buffer_load_dwordx4 v10, s[16:19], s7 offen lds
s_waitcnt lgkmcnt(0)
v_mfma_f32_32x32x16_bf16 v[64:79], a[192:195], a[0:3], v[64:79]
ds_read_b64_tr_b16 a[208:209], v20 offset:28672
ds_read_b64_tr_b16 a[210:211], v20 offset:29696
ds_read_b64_tr_b16 a[212:213], v21 offset:28672
ds_read_b128 a[16:19], v16 offset:8192
ds_read_b128 a[20:23], v17 offset:8192
s_add_u32 m0, s41, 73728
v_mfma_f32_32x32x16_bf16 v[80:95], a[196:199], a[0:3], v[80:95]
buffer_load_dwordx4 v8, s[16:19], s8 offen lds
ds_read_b64_tr_b16 a[214:215], v21 offset:29696
ds_read_b64_tr_b16 a[216:217], v20 offset:30720
ds_read_b64_tr_b16 a[218:219], v20 offset:31744
s_add_u32 m0, s47, 4096
v_mfma_f32_32x32x16_bf16 v[64:79], a[200:203], a[4:7], v[64:79]
buffer_load_dwordx4 v12, s[20:23], s84 offen offset:0 lds
ds_read_b64_tr_b16 a[220:221], v21 offset:30720
ds_read_b64_tr_b16 a[222:223], v21 offset:31744
v_mfma_f32_32x32x16_bf16 v[80:95], a[204:207], a[4:7], v[80:95]
buffer_load_dwordx4 v13, s[20:23], s84 offen offset:1024 lds
ds_read_b128 a[24:27], v18 offset:8192
s_waitcnt lgkmcnt(1)
v_mfma_f32_32x32x16_bf16 v[64:79], a[208:211], a[8:11], v[64:79]
ds_read_b64_tr_b16 a[192:193], v20 offset:32768
ds_read_b64_tr_b16 a[194:195], v20 offset:33792
ds_read_b64_tr_b16 a[196:197], v21 offset:32768
ds_read_b128 a[28:31], v19 offset:8192
v_mfma_f32_32x32x16_bf16 v[80:95], a[212:215], a[8:11], v[80:95]
buffer_load_dwordx4 v14, s[20:23], s84 offen offset:2048 lds
ds_read_b64_tr_b16 a[198:199], v21 offset:33792
ds_read_b64_tr_b16 a[200:201], v20 offset:34816
ds_read_b64_tr_b16 a[202:203], v20 offset:35840
v_mfma_f32_32x32x16_bf16 v[64:79], a[216:219], a[12:15], v[64:79]
buffer_load_dwordx4 v15, s[20:23], s84 offen offset:3072 lds
ds_read_b64_tr_b16 a[204:205], v21 offset:34816
ds_read_b64_tr_b16 a[206:207], v21 offset:35840
s_add_u32 m0, s41, 77824
v_mfma_f32_32x32x16_bf16 v[80:95], a[220:223], a[12:15], v[80:95]
buffer_load_dwordx4 v10, s[16:19], s8 offen lds
s_waitcnt lgkmcnt(0)
v_mfma_f32_32x32x16_bf16 v[32:47], a[192:195], a[16:19], v[32:47]
ds_read_b64_tr_b16 a[208:209], v20 offset:36864
ds_read_b64_tr_b16 a[210:211], v20 offset:37888
ds_read_b64_tr_b16 a[212:213], v21 offset:36864
s_waitcnt vmcnt(9)
ds_read_b128 a[32:35], v16 offset:0
s_add_u32 m0, s41, 81920
v_mfma_f32_32x32x16_bf16 v[48:63], a[196:199], a[16:19], v[48:63]
buffer_load_dwordx4 v8, s[16:19], s9 offen lds
ds_read_b64_tr_b16 a[214:215], v21 offset:37888
ds_read_b64_tr_b16 a[216:217], v20 offset:38912
ds_read_b64_tr_b16 a[218:219], v20 offset:39936
s_add_u32 m0, s47, 8192
v_mfma_f32_32x32x16_bf16 v[32:47], a[200:203], a[20:23], v[32:47]
buffer_load_dwordx4 v12, s[20:23], s85 offen offset:0 lds
ds_read_b64_tr_b16 a[220:221], v21 offset:38912
ds_read_b64_tr_b16 a[222:223], v21 offset:39936
v_mfma_f32_32x32x16_bf16 v[48:63], a[204:207], a[20:23], v[48:63]
buffer_load_dwordx4 v13, s[20:23], s85 offen offset:1024 lds
ds_read_b128 a[36:39], v17 offset:0
s_waitcnt lgkmcnt(1)
v_mfma_f32_32x32x16_bf16 v[32:47], a[208:211], a[24:27], v[32:47]
ds_read_b64_tr_b16 a[192:193], v20 offset:40960
ds_read_b64_tr_b16 a[194:195], v20 offset:41984
ds_read_b64_tr_b16 a[196:197], v21 offset:40960
ds_read_b128 a[40:43], v18 offset:0
ds_read_b128 a[44:47], v19 offset:0
v_mfma_f32_32x32x16_bf16 v[48:63], a[212:215], a[24:27], v[48:63]
buffer_load_dwordx4 v14, s[20:23], s85 offen offset:2048 lds
ds_read_b64_tr_b16 a[198:199], v21 offset:41984
ds_read_b64_tr_b16 a[200:201], v20 offset:43008
ds_read_b64_tr_b16 a[202:203], v20 offset:44032
v_mfma_f32_32x32x16_bf16 v[32:47], a[216:219], a[28:31], v[32:47]
buffer_load_dwordx4 v15, s[20:23], s85 offen offset:3072 lds
ds_read_b64_tr_b16 a[204:205], v21 offset:43008
ds_read_b64_tr_b16 a[206:207], v21 offset:44032
s_add_u32 m0, s41, 86016
v_mfma_f32_32x32x16_bf16 v[48:63], a[220:223], a[28:31], v[48:63]
buffer_load_dwordx4 v10, s[16:19], s9 offen lds
s_waitcnt lgkmcnt(0)
v_mfma_f32_32x32x16_bf16 v[64:79], a[192:195], a[16:19], v[64:79]
ds_read_b64_tr_b16 a[208:209], v20 offset:45056
ds_read_b64_tr_b16 a[210:211], v20 offset:46080
ds_read_b64_tr_b16 a[212:213], v21 offset:45056
v_permlane32_swap_b32 v161, v163
s_add_u32 m0, s41, 90112
v_mfma_f32_32x32x16_bf16 v[80:95], a[196:199], a[16:19], v[80:95]
buffer_load_dwordx4 v8, s[16:19], s10 offen lds
ds_read_b64_tr_b16 a[214:215], v21 offset:46080
ds_read_b64_tr_b16 a[216:217], v20 offset:47104
ds_read_b64_tr_b16 a[218:219], v20 offset:48128
s_add_u32 m0, s47, 0
v_mfma_f32_32x32x16_bf16 v[64:79], a[200:203], a[20:23], v[64:79]
buffer_load_dwordx4 v12, s[20:23], s86 offen offset:0 lds
ds_read_b64_tr_b16 a[220:221], v21 offset:47104
ds_read_b64_tr_b16 a[222:223], v21 offset:48128
v_mfma_f32_32x32x16_bf16 v[80:95], a[204:207], a[20:23], v[80:95]
buffer_load_dwordx4 v13, s[20:23], s86 offen offset:1024 lds
s_waitcnt vmcnt(15) lgkmcnt(0)
v_mfma_f32_32x32x16_bf16 v[64:79], a[208:211], a[24:27], v[64:79]
s_barrier
ds_read_b64_tr_b16 a[192:193], v20 offset:49152
ds_read_b64_tr_b16 a[194:195], v20 offset:50176
v_mfma_f32_32x32x16_bf16 v[80:95], a[212:215], a[24:27], v[80:95]
buffer_load_dwordx4 v14, s[20:23], s86 offen offset:2048 lds
ds_read_b64_tr_b16 a[196:197], v21 offset:49152
ds_read_b64_tr_b16 a[198:199], v21 offset:50176
ds_read_b64_tr_b16 a[200:201], v20 offset:51200
v_mfma_f32_32x32x16_bf16 v[64:79], a[216:219], a[28:31], v[64:79]
buffer_load_dwordx4 v15, s[20:23], s86 offen offset:3072 lds
ds_read_b64_tr_b16 a[202:203], v20 offset:52224
ds_read_b64_tr_b16 a[204:205], v21 offset:51200
ds_read_b64_tr_b16 a[206:207], v21 offset:52224
s_add_u32 m0, s41, 94208
v_mfma_f32_32x32x16_bf16 v[80:95], a[220:223], a[28:31], v[80:95]
buffer_load_dwordx4 v10, s[16:19], s10 offen lds
s_waitcnt vmcnt(13)
ds_read_b128 a[48:51], v16 offset:4096
s_waitcnt lgkmcnt(1)
v_mfma_f32_32x32x16_bf16 v[32:47], a[192:195], a[32:35], v[32:47]
ds_read_b64_tr_b16 a[208:209], v20 offset:53248
ds_read_b64_tr_b16 a[210:211], v20 offset:54272
ds_read_b64_tr_b16 a[212:213], v21 offset:53248
ds_read_b128 a[52:55], v17 offset:4096
ds_read_b128 a[56:59], v18 offset:4096
s_add_u32 m0, s41, 98304
v_mfma_f32_32x32x16_bf16 v[48:63], a[196:199], a[32:35], v[48:63]
buffer_load_dwordx4 v8, s[16:19], s11 offen lds
ds_read_b64_tr_b16 a[214:215], v21 offset:54272
ds_read_b64_tr_b16 a[216:217], v20 offset:55296
ds_read_b64_tr_b16 a[218:219], v20 offset:56320
s_add_u32 m0, s41, 102400
v_mfma_f32_32x32x16_bf16 v[32:47], a[200:203], a[36:39], v[32:47]
buffer_load_dwordx4 v10, s[16:19], s11 offen lds
ds_read_b64_tr_b16 a[220:221], v21 offset:55296
ds_read_b64_tr_b16 a[222:223], v21 offset:56320
s_add_u32 m0, s41, 106496
v_mfma_f32_32x32x16_bf16 v[48:63], a[204:207], a[36:39], v[48:63]
buffer_load_dwordx4 v8, s[16:19], s12 offen lds
ds_read_b128 a[60:63], v19 offset:4096
s_waitcnt lgkmcnt(1)
v_mfma_f32_32x32x16_bf16 v[32:47], a[208:211], a[40:43], v[32:47]
ds_read_b64_tr_b16 a[192:193], v20 offset:57344
ds_read_b64_tr_b16 a[194:195], v20 offset:58368
ds_read_b64_tr_b16 a[196:197], v21 offset:57344
s_waitcnt vmcnt(10)
ds_read_b128 a[64:67], v16 offset:8192
s_waitcnt lgkmcnt(4)
s_add_u32 m0, s47, 4096
v_mfma_f32_32x32x16_bf16 v[48:63], a[212:215], a[40:43], v[48:63]
buffer_load_dwordx4 v12, s[20:23], s87 offen offset:0 lds
ds_read_b64_tr_b16 a[198:199], v21 offset:58368
ds_read_b64_tr_b16 a[200:201], v20 offset:59392
ds_read_b64_tr_b16 a[202:203], v20 offset:60416
v_mfma_f32_32x32x16_bf16 v[32:47], a[216:219], a[44:47], v[32:47]
buffer_load_dwordx4 v13, s[20:23], s87 offen offset:1024 lds
ds_read_b64_tr_b16 a[204:205], v21 offset:59392
ds_read_b64_tr_b16 a[206:207], v21 offset:60416
v_mfma_f32_32x32x16_bf16 v[48:63], a[220:223], a[44:47], v[48:63]
buffer_load_dwordx4 v14, s[20:23], s87 offen offset:2048 lds
v_lshlrev_b32 v96, 16, v160
s_waitcnt lgkmcnt(0)
v_mfma_f32_32x32x16_bf16 v[64:79], a[192:195], a[32:35], v[64:79]
ds_read_b64_tr_b16 a[208:209], v20 offset:61440
ds_read_b64_tr_b16 a[210:211], v20 offset:62464
ds_read_b64_tr_b16 a[212:213], v21 offset:61440
ds_read_b128 a[68:71], v17 offset:8192
ds_read_b128 a[72:75], v18 offset:8192
v_mfma_f32_32x32x16_bf16 v[80:95], a[196:199], a[32:35], v[80:95]
buffer_load_dwordx4 v15, s[20:23], s87 offen offset:3072 lds
ds_read_b64_tr_b16 a[214:215], v21 offset:62464
ds_read_b64_tr_b16 a[216:217], v20 offset:63488
ds_read_b64_tr_b16 a[218:219], v20 offset:64512
v_and_b32 v97, 0xffff0000, v160
s_add_u32 m0, s41, 0
v_mfma_f32_32x32x16_bf16 v[64:79], a[200:203], a[36:39], v[64:79]
buffer_load_dwordx4 v10, s[16:19], s12 offen lds
ds_read_b64_tr_b16 a[220:221], v21 offset:63488
ds_read_b64_tr_b16 a[222:223], v21 offset:64512
s_add_u32 m0, s41, 4096
v_mfma_f32_32x32x16_bf16 v[80:95], a[204:207], a[36:39], v[80:95]
buffer_load_dwordx4 v8, s[16:19], s13 offen lds
v_lshlrev_b32 v98, 16, v161
s_waitcnt lgkmcnt(0)
v_mfma_f32_32x32x16_bf16 v[64:79], a[208:211], a[40:43], v[64:79]
ds_read_b64_tr_b16 a[192:193], v22 offset:0
ds_read_b64_tr_b16 a[194:195], v22 offset:1024
ds_read_b64_tr_b16 a[196:197], v23 offset:0
ds_read_b128 a[76:79], v19 offset:8192
s_waitcnt vmcnt(10)
ds_read_b128 a[80:83], v16 offset:0
v_mfma_f32_32x32x16_bf16 v[80:95], a[212:215], a[40:43], v[80:95]
ds_read_b64_tr_b16 a[198:199], v23 offset:1024
ds_read_b64_tr_b16 a[200:201], v22 offset:2048
ds_read_b64_tr_b16 a[202:203], v22 offset:3072
v_and_b32 v99, 0xffff0000, v161
ds_read_b128 a[84:87], v17 offset:0
s_waitcnt lgkmcnt(5)
s_add_u32 m0, s47, 8192
v_mfma_f32_32x32x16_bf16 v[64:79], a[216:219], a[44:47], v[64:79]
buffer_load_dwordx4 v12, s[20:23], s88 offen offset:0 lds
ds_read_b64_tr_b16 a[204:205], v23 offset:2048
ds_read_b64_tr_b16 a[206:207], v23 offset:3072
v_mfma_f32_32x32x16_bf16 v[80:95], a[220:223], a[44:47], v[80:95]
buffer_load_dwordx4 v13, s[20:23], s88 offen offset:1024 lds
v_lshlrev_b32 v100, 16, v162
s_waitcnt lgkmcnt(0)
v_mfma_f32_32x32x16_bf16 v[32:47], a[192:195], a[48:51], v[32:47]
ds_read_b64_tr_b16 a[208:209], v22 offset:4096
ds_read_b64_tr_b16 a[210:211], v22 offset:5120
ds_read_b64_tr_b16 a[212:213], v23 offset:4096
ds_read_b128 a[88:91], v18 offset:0
ds_read_b128 a[92:95], v19 offset:0
v_mfma_f32_32x32x16_bf16 v[48:63], a[196:199], a[48:51], v[48:63]
buffer_load_dwordx4 v14, s[20:23], s88 offen offset:2048 lds
ds_read_b64_tr_b16 a[214:215], v23 offset:5120
ds_read_b64_tr_b16 a[216:217], v22 offset:6144
ds_read_b64_tr_b16 a[218:219], v22 offset:7168
v_and_b32 v101, 0xffff0000, v162
v_mfma_f32_32x32x16_bf16 v[32:47], a[200:203], a[52:55], v[32:47]
buffer_load_dwordx4 v15, s[20:23], s88 offen offset:3072 lds
ds_read_b64_tr_b16 a[220:221], v23 offset:6144
ds_read_b64_tr_b16 a[222:223], v23 offset:7168
s_waitcnt lgkmcnt(5)
s_add_u32 m0, s47, 0
v_mfma_f32_32x32x16_bf16 v[48:63], a[204:207], a[52:55], v[48:63]
buffer_load_dwordx4 v12, s[20:23], s89 offen offset:0 lds
v_lshlrev_b32 v102, 16, v163
s_waitcnt vmcnt(14) lgkmcnt(0)
v_mfma_f32_32x32x16_bf16 v[32:47], a[208:211], a[56:59], v[32:47]
s_barrier
ds_read_b64_tr_b16 a[192:193], v22 offset:8192
ds_read_b64_tr_b16 a[194:195], v22 offset:9216
v_mfma_f32_32x32x16_bf16 v[48:63], a[212:215], a[56:59], v[48:63]
buffer_load_dwordx4 v13, s[20:23], s89 offen offset:1024 lds
ds_read_b64_tr_b16 a[196:197], v23 offset:8192
ds_read_b64_tr_b16 a[198:199], v23 offset:9216
ds_read_b64_tr_b16 a[200:201], v22 offset:10240
v_and_b32 v103, 0xffff0000, v163
v_mfma_f32_32x32x16_bf16 v[32:47], a[216:219], a[60:63], v[32:47]
buffer_load_dwordx4 v14, s[20:23], s89 offen offset:2048 lds
ds_read_b64_tr_b16 a[202:203], v22 offset:11264
ds_read_b64_tr_b16 a[204:205], v23 offset:10240
ds_read_b64_tr_b16 a[206:207], v23 offset:11264
v_mfma_f32_32x32x16_bf16 v[48:63], a[220:223], a[60:63], v[48:63]
buffer_load_dwordx4 v15, s[20:23], s89 offen offset:3072 lds
v_permlane32_swap_b32 v164, v166
s_waitcnt lgkmcnt(0)
v_mfma_f32_32x32x16_bf16 v[32:47], a[192:195], a[64:67], v[32:47]
ds_read_b64_tr_b16 a[208:209], v22 offset:12288
ds_read_b64_tr_b16 a[210:211], v22 offset:13312
ds_read_b64_tr_b16 a[212:213], v23 offset:12288
s_waitcnt vmcnt(10)
ds_read_b128 v[176:179], v16 offset:4096
s_add_u32 m0, s41, 8192
v_mfma_f32_32x32x16_bf16 v[48:63], a[196:199], a[64:67], v[48:63]
buffer_load_dwordx4 v10, s[16:19], s13 offen lds
ds_read_b64_tr_b16 a[214:215], v23 offset:13312
ds_read_b64_tr_b16 a[216:217], v22 offset:14336
ds_read_b64_tr_b16 a[218:219], v22 offset:15360
v_permlane32_swap_b32 v165, v167
s_add_u32 m0, s41, 12288
v_mfma_f32_32x32x16_bf16 v[32:47], a[200:203], a[68:71], v[32:47]
buffer_load_dwordx4 v8, s[16:19], s14 offen lds
ds_read_b64_tr_b16 a[220:221], v23 offset:14336
ds_read_b64_tr_b16 a[222:223], v23 offset:15360
s_add_u32 m0, s41, 16384
v_mfma_f32_32x32x16_bf16 v[48:63], a[204:207], a[68:71], v[48:63]
buffer_load_dwordx4 v10, s[16:19], s14 offen lds
v_lshlrev_b32 v104, 16, v164
s_waitcnt lgkmcnt(0)
v_mfma_f32_32x32x16_bf16 v[32:47], a[208:211], a[72:75], v[32:47]
ds_read_b64_tr_b16 a[192:193], v22 offset:16384
ds_read_b64_tr_b16 a[194:195], v22 offset:17408
ds_read_b64_tr_b16 a[196:197], v23 offset:16384
ds_read_b128 v[180:183], v17 offset:4096
ds_read_b128 v[184:187], v18 offset:4096
v_mfma_f32_32x32x16_bf16 v[48:63], a[212:215], a[72:75], v[48:63]
ds_read_b64_tr_b16 a[198:199], v23 offset:17408
ds_read_b64_tr_b16 a[200:201], v22 offset:18432
ds_read_b64_tr_b16 a[202:203], v22 offset:19456
v_and_b32 v105, 0xffff0000, v164
ds_read_b128 v[188:191], v19 offset:4096
s_add_u32 m0, s41, 20480
v_mfma_f32_32x32x16_bf16 v[32:47], a[216:219], a[76:79], v[32:47]
buffer_load_dwordx4 v8, s[16:19], s15 offen lds
ds_read_b64_tr_b16 a[204:205], v23 offset:18432
ds_read_b64_tr_b16 a[206:207], v23 offset:19456
s_waitcnt lgkmcnt(2)
s_add_u32 m0, s47, 4096
v_mfma_f32_32x32x16_bf16 v[48:63], a[220:223], a[76:79], v[48:63]
buffer_load_dwordx4 v12, s[20:23], s90 offen offset:0 lds
v_lshlrev_b32 v106, 16, v165
s_waitcnt lgkmcnt(0)
v_mfma_f32_32x32x16_bf16 v[32:47], a[192:195], a[80:83], v[32:47]
ds_read_b64_tr_b16 a[208:209], v22 offset:20480
ds_read_b64_tr_b16 a[210:211], v22 offset:21504
ds_read_b64_tr_b16 a[212:213], v23 offset:20480
s_waitcnt vmcnt(9)
ds_read_b128 a[96:99], v16 offset:8192
ds_read_b128 a[100:103], v17 offset:8192
v_mfma_f32_32x32x16_bf16 v[48:63], a[196:199], a[80:83], v[48:63]
s_mov_b32 s45, 65536
buffer_load_dwordx2 v[0:1], v30, s[24:27], s45 offen sc1
ds_read_b64_tr_b16 a[214:215], v23 offset:21504
ds_read_b64_tr_b16 a[216:217], v22 offset:22528
ds_read_b64_tr_b16 a[218:219], v22 offset:23552
v_and_b32 v107, 0xffff0000, v165
v_mfma_f32_32x32x16_bf16 v[32:47], a[200:203], a[84:87], v[32:47]
buffer_load_dwordx4 v13, s[20:23], s90 offen offset:1024 lds
ds_read_b64_tr_b16 a[220:221], v23 offset:22528
ds_read_b64_tr_b16 a[222:223], v23 offset:23552
v_mfma_f32_32x32x16_bf16 v[48:63], a[204:207], a[84:87], v[48:63]
buffer_load_dwordx4 v14, s[20:23], s90 offen offset:2048 lds
v_lshlrev_b32 v108, 16, v166
s_waitcnt lgkmcnt(0)
v_mfma_f32_32x32x16_bf16 v[32:47], a[208:211], a[88:91], v[32:47]
ds_read_b64_tr_b16 a[192:193], v22 offset:24576
ds_read_b64_tr_b16 a[194:195], v22 offset:25600
ds_read_b64_tr_b16 a[196:197], v23 offset:24576
ds_read_b128 a[104:107], v18 offset:8192
ds_read_b128 a[108:111], v19 offset:8192
v_mfma_f32_32x32x16_bf16 v[48:63], a[212:215], a[88:91], v[48:63]
buffer_load_dwordx4 v15, s[20:23], s90 offen offset:3072 lds
ds_read_b64_tr_b16 a[198:199], v23 offset:25600
ds_read_b64_tr_b16 a[200:201], v22 offset:26624
ds_read_b64_tr_b16 a[202:203], v22 offset:27648
v_and_b32 v109, 0xffff0000, v166
s_waitcnt lgkmcnt(3)
s_add_u32 m0, s47, 8192
v_mfma_f32_32x32x16_bf16 v[32:47], a[216:219], a[92:95], v[32:47]
buffer_load_dwordx4 v12, s[20:23], s91 offen offset:0 lds
ds_read_b64_tr_b16 a[204:205], v23 offset:26624
ds_read_b64_tr_b16 a[206:207], v23 offset:27648
v_mfma_f32_32x32x16_bf16 v[48:63], a[220:223], a[92:95], v[48:63]
buffer_load_dwordx4 v13, s[20:23], s91 offen offset:1024 lds
v_lshlrev_b32 v110, 16, v167
s_waitcnt lgkmcnt(0)
v_mfma_f32_32x32x16_bf16 v[32:47], a[192:195], v[176:179], v[32:47]
ds_read_b64_tr_b16 a[208:209], v22 offset:28672
ds_read_b64_tr_b16 a[210:211], v22 offset:29696
ds_read_b64_tr_b16 a[212:213], v23 offset:28672
s_waitcnt vmcnt(11)
ds_read_b128 a[112:115], v16 offset:0
v_mfma_f32_32x32x16_bf16 v[48:63], a[196:199], v[176:179], v[48:63]
buffer_load_dwordx4 v14, s[20:23], s91 offen offset:2048 lds
ds_read_b64_tr_b16 a[214:215], v23 offset:29696
ds_read_b64_tr_b16 a[216:217], v22 offset:30720
ds_read_b64_tr_b16 a[218:219], v22 offset:31744
v_and_b32 v111, 0xffff0000, v167
v_mfma_f32_32x32x16_bf16 v[32:47], a[200:203], v[180:183], v[32:47]
buffer_load_dwordx4 v15, s[20:23], s91 offen offset:3072 lds
ds_read_b64_tr_b16 a[220:221], v23 offset:30720
ds_read_b64_tr_b16 a[222:223], v23 offset:31744
s_add_u32 m0, s41, 24576
v_mfma_f32_32x32x16_bf16 v[48:63], a[204:207], v[180:183], v[48:63]
buffer_load_dwordx4 v10, s[16:19], s15 offen lds
ds_read_b128 a[116:119], v17 offset:0
s_waitcnt vmcnt(13) lgkmcnt(1)
v_mfma_f32_32x32x16_bf16 v[32:47], a[208:211], v[184:187], v[32:47]
s_barrier
ds_read_b64_tr_b16 a[192:193], v22 offset:32768
ds_read_b64_tr_b16 a[194:195], v22 offset:33792
v_permlane32_swap_b32 v168, v170
s_add_u32 m0, s41, 28672
v_mfma_f32_32x32x16_bf16 v[48:63], a[212:215], v[184:187], v[48:63]
buffer_load_dwordx4 v9, s[16:19], s7 offen lds
ds_read_b64_tr_b16 a[196:197], v23 offset:32768
ds_read_b64_tr_b16 a[198:199], v23 offset:33792
ds_read_b64_tr_b16 a[200:201], v22 offset:34816
s_add_u32 m0, s41, 32768
v_mfma_f32_32x32x16_bf16 v[32:47], a[216:219], v[188:191], v[32:47]
buffer_load_dwordx4 v11, s[16:19], s7 offen lds
ds_read_b64_tr_b16 a[202:203], v22 offset:35840
ds_read_b64_tr_b16 a[204:205], v23 offset:34816
ds_read_b64_tr_b16 a[206:207], v23 offset:35840
v_permlane32_swap_b32 v169, v171
s_add_u32 m0, s41, 36864
v_mfma_f32_32x32x16_bf16 v[48:63], a[220:223], v[188:191], v[48:63]
buffer_load_dwordx4 v9, s[16:19], s8 offen lds
ds_read_b128 a[120:123], v18 offset:0
s_waitcnt lgkmcnt(1)
v_mfma_f32_32x32x16_bf16 v[32:47], a[192:195], a[96:99], v[32:47]
ds_read_b64_tr_b16 a[208:209], v22 offset:36864
ds_read_b64_tr_b16 a[210:211], v22 offset:37888
ds_read_b64_tr_b16 a[212:213], v23 offset:36864
v_lshlrev_b32 v112, 16, v168
ds_read_b128 a[124:127], v19 offset:0
v_mfma_f32_32x32x16_bf16 v[48:63], a[196:199], a[96:99], v[48:63]
ds_read_b64_tr_b16 a[214:215], v23 offset:37888
ds_read_b64_tr_b16 a[216:217], v22 offset:38912
ds_read_b64_tr_b16 a[218:219], v22 offset:39936
s_waitcnt vmcnt(11)
L_mr_sp99:
v_subrev_u32 v2, s49, v1
v_lshrrev_b32 v2, 4, v2
v_xor_b32 v3, s48, v0
v_xor_b32 v2, 1, v2
v_or_b32 v2, v2, v3
v_cmp_eq_u32 vcc, 0, v2
s_nop 1
s_and_b32 s44, vcc_lo, 127
s_cmp_eq_u32 s44, 127
s_cbranch_scc0 L_mr_ok99x
L_mr_ok99:
v_cmp_eq_u32 vcc, s33, v1
s_nop 1
s_and_b32 s44, s44, vcc_lo
s_cmp_eq_u32 s44, 0x7f
s_cselect_b32 s32, 1, 0
s_cselect_b32 s93, 0, 8388608
s_waitcnt lgkmcnt(3)
s_add_u32 m0, s47, 0
v_mfma_f32_32x32x16_bf16 v[32:47], a[200:203], a[100:103], v[32:47]
buffer_load_dwordx4 v12, s[20:23], s92 offen offset:0 lds
ds_read_b64_tr_b16 a[220:221], v23 offset:38912
ds_read_b64_tr_b16 a[222:223], v23 offset:39936
v_and_b32 v113, 0xffff0000, v168
v_mfma_f32_32x32x16_bf16 v[48:63], a[204:207], a[100:103], v[48:63]
buffer_load_dwordx4 v13, s[20:23], s92 offen offset:1024 lds
s_waitcnt lgkmcnt(0)
v_mfma_f32_32x32x16_bf16 v[32:47], a[208:211], a[104:107], v[32:47]
ds_read_b64_tr_b16 a[192:193], v22 offset:40960
ds_read_b64_tr_b16 a[194:195], v22 offset:41984
ds_read_b64_tr_b16 a[196:197], v23 offset:40960
v_lshlrev_b32 v114, 16, v169
s_waitcnt vmcnt(10)
ds_read_b128 a[128:131], v16 offset:4096
v_mfma_f32_32x32x16_bf16 v[48:63], a[212:215], a[104:107], v[48:63]
buffer_load_dwordx4 v14, s[20:23], s92 offen offset:2048 lds
ds_read_b64_tr_b16 a[198:199], v23 offset:41984
ds_read_b64_tr_b16 a[200:201], v22 offset:43008
ds_read_b64_tr_b16 a[202:203], v22 offset:44032
v_mfma_f32_32x32x16_bf16 v[32:47], a[216:219], a[108:111], v[32:47]
buffer_load_dwordx4 v15, s[20:23], s92 offen offset:3072 lds
ds_read_b64_tr_b16 a[204:205], v23 offset:43008
ds_read_b64_tr_b16 a[206:207], v23 offset:44032
v_and_b32 v115, 0xffff0000, v169
s_add_u32 m0, s41, 40960
v_mfma_f32_32x32x16_bf16 v[48:63], a[220:223], a[108:111], v[48:63]
buffer_load_dwordx4 v11, s[16:19], s8 offen lds
ds_read_b128 a[132:135], v17 offset:4096
s_waitcnt lgkmcnt(1)
v_mfma_f32_32x32x16_bf16 v[32:47], a[192:195], a[112:115], v[32:47]
ds_read_b64_tr_b16 a[208:209], v20 offset:0
ds_read_b64_tr_b16 a[210:211], v20 offset:1024
ds_read_b64_tr_b16 a[212:213], v21 offset:0
v_lshlrev_b32 v116, 16, v170
ds_read_b128 a[136:139], v18 offset:4096
s_add_u32 m0, s41, 45056
v_mfma_f32_32x32x16_bf16 v[48:63], a[196:199], a[112:115], v[48:63]
buffer_load_dwordx4 v9, s[16:19], s9 offen lds
ds_read_b64_tr_b16 a[214:215], v21 offset:1024
ds_read_b64_tr_b16 a[216:217], v20 offset:2048
ds_read_b64_tr_b16 a[218:219], v20 offset:3072
s_add_u32 m0, s41, 49152
v_mfma_f32_32x32x16_bf16 v[32:47], a[200:203], a[116:119], v[32:47]
buffer_load_dwordx4 v11, s[16:19], s9 offen lds
ds_read_b64_tr_b16 a[220:221], v21 offset:2048
ds_read_b64_tr_b16 a[222:223], v21 offset:3072
v_and_b32 v117, 0xffff0000, v170
s_add_u32 m0, s41, 53248
v_mfma_f32_32x32x16_bf16 v[48:63], a[204:207], a[116:119], v[48:63]
buffer_load_dwordx4 v9, s[16:19], s10 offen lds
ds_read_b128 a[140:143], v19 offset:4096
s_waitcnt lgkmcnt(1)
v_mfma_f32_32x32x16_bf16 v[32:47], a[208:211], a[120:123], v[32:47]
ds_read_b64_tr_b16 a[192:193], v20 offset:4096
ds_read_b64_tr_b16 a[194:195], v20 offset:5120
ds_read_b64_tr_b16 a[196:197], v21 offset:4096
v_lshlrev_b32 v118, 16, v171
s_waitcnt vmcnt(12)
ds_read_b128 a[144:147], v16 offset:8192
v_mfma_f32_32x32x16_bf16 v[48:63], a[212:215], a[120:123], v[48:63]
ds_read_b64_tr_b16 a[198:199], v21 offset:5120
ds_read_b64_tr_b16 a[200:201], v20 offset:6144
ds_read_b64_tr_b16 a[202:203], v20 offset:7168
ds_read_b128 a[148:151], v17 offset:8192
ds_read_b128 a[152:155], v18 offset:8192
s_add_u32 m0, s41, 57344
v_mfma_f32_32x32x16_bf16 v[32:47], a[216:219], a[124:127], v[32:47]
buffer_load_dwordx4 v11, s[16:19], s10 offen lds
ds_read_b64_tr_b16 a[204:205], v21 offset:6144
ds_read_b64_tr_b16 a[206:207], v21 offset:7168
v_and_b32 v119, 0xffff0000, v171
s_add_u32 m0, s41, 61440
v_mfma_f32_32x32x16_bf16 v[48:63], a[220:223], a[124:127], v[48:63]
buffer_load_dwordx4 v9, s[16:19], s11 offen lds
ds_read_b128 a[156:159], v19 offset:8192
s_waitcnt lgkmcnt(1)
v_mfma_f32_32x32x16_bf16 v[32:47], a[192:195], a[128:131], v[32:47]
ds_read_b64_tr_b16 a[208:209], v20 offset:8192
ds_read_b64_tr_b16 a[210:211], v20 offset:9216
ds_read_b64_tr_b16 a[212:213], v21 offset:8192
v_permlane32_swap_b32 v172, v174
v_permlane32_swap_b32 v173, v175
v_mfma_f32_32x32x16_bf16 v[48:63], a[196:199], a[128:131], v[48:63]
ds_read_b64_tr_b16 a[214:215], v21 offset:9216
ds_read_b64_tr_b16 a[216:217], v20 offset:10240
ds_read_b64_tr_b16 a[218:219], v20 offset:11264
v_lshlrev_b32 v120, 16, v172
s_add_u32 m0, s41, 65536
v_mfma_f32_32x32x16_bf16 v[32:47], a[200:203], a[132:135], v[32:47]
buffer_load_dwordx4 v11, s[16:19], s11 offen lds
ds_read_b64_tr_b16 a[220:221], v21 offset:10240
ds_read_b64_tr_b16 a[222:223], v21 offset:11264
v_and_b32 v121, 0xffff0000, v172
s_add_u32 m0, s41, 69632
v_mfma_f32_32x32x16_bf16 v[48:63], a[204:207], a[132:135], v[48:63]
buffer_load_dwordx4 v9, s[16:19], s12 offen lds
s_waitcnt vmcnt(13) lgkmcnt(0)
v_mfma_f32_32x32x16_bf16 v[32:47], a[208:211], a[136:139], v[32:47]
s_barrier
ds_read_b64_tr_b16 a[192:193], v20 offset:12288
ds_read_b64_tr_b16 a[194:195], v20 offset:13312
s_waitcnt vmcnt(8)
ds_read_b128 a[160:163], v16 offset:0
v_mfma_f32_32x32x16_bf16 v[48:63], a[212:215], a[136:139], v[48:63]
ds_read_b64_tr_b16 a[196:197], v21 offset:12288
ds_read_b64_tr_b16 a[198:199], v21 offset:13312
ds_read_b64_tr_b16 a[200:201], v20 offset:14336
v_lshlrev_b32 v122, 16, v173
ds_read_b128 a[164:167], v17 offset:0
s_add_u32 m0, s41, 73728
v_mfma_f32_32x32x16_bf16 v[32:47], a[216:219], a[140:143], v[32:47]
buffer_load_dwordx4 v11, s[16:19], s12 offen lds
ds_read_b64_tr_b16 a[202:203], v20 offset:15360
ds_read_b64_tr_b16 a[204:205], v21 offset:14336
ds_read_b64_tr_b16 a[206:207], v21 offset:15360
s_add_u32 m0, s41, 77824
v_mfma_f32_32x32x16_bf16 v[48:63], a[220:223], a[140:143], v[48:63]
buffer_load_dwordx4 v9, s[16:19], s13 offen lds
ds_read_b128 a[168:171], v18 offset:0
s_waitcnt lgkmcnt(1)
v_mfma_f32_32x32x16_bf16 v[32:47], a[192:195], a[144:147], v[32:47]
ds_read_b64_tr_b16 a[208:209], v20 offset:16384
ds_read_b64_tr_b16 a[210:211], v20 offset:17408
ds_read_b64_tr_b16 a[212:213], v21 offset:16384
v_and_b32 v123, 0xffff0000, v173
ds_read_b128 a[172:175], v19 offset:0
v_mfma_f32_32x32x16_bf16 v[48:63], a[196:199], a[144:147], v[48:63]
ds_read_b64_tr_b16 a[214:215], v21 offset:17408
ds_read_b64_tr_b16 a[216:217], v20 offset:18432
ds_read_b64_tr_b16 a[218:219], v20 offset:19456
v_lshlrev_b32 v124, 16, v174
s_add_u32 m0, s41, 81920
v_mfma_f32_32x32x16_bf16 v[32:47], a[200:203], a[148:151], v[32:47]
buffer_load_dwordx4 v11, s[16:19], s13 offen lds
ds_read_b64_tr_b16 a[220:221], v21 offset:18432
ds_read_b64_tr_b16 a[222:223], v21 offset:19456
v_and_b32 v125, 0xffff0000, v174
s_add_u32 m0, s41, 86016
v_mfma_f32_32x32x16_bf16 v[48:63], a[204:207], a[148:151], v[48:63]
buffer_load_dwordx4 v9, s[16:19], s14 offen lds
s_waitcnt lgkmcnt(0)
s_waitcnt lgkmcnt(0)
v_mfma_f32_32x32x16_bf16 v[32:47], a[208:211], a[152:155], v[32:47]
ds_read_b64_tr_b16 a[192:193], v20 offset:20480
ds_read_b64_tr_b16 a[194:195], v20 offset:21504
ds_read_b64_tr_b16 a[196:197], v21 offset:20480
v_lshlrev_b32 v126, 16, v175
v_and_b32 v127, 0xffff0000, v175
v_mfma_f32_32x32x16_bf16 v[48:63], a[212:215], a[152:155], v[48:63]
ds_read_b64_tr_b16 a[198:199], v21 offset:21504
ds_read_b64_tr_b16 a[200:201], v20 offset:22528
ds_read_b64_tr_b16 a[202:203], v20 offset:23552
s_add_u32 m0, s41, 90112
v_mfma_f32_32x32x16_bf16 v[32:47], a[216:219], a[156:159], v[32:47]
buffer_load_dwordx4 v11, s[16:19], s14 offen lds
ds_read_b64_tr_b16 a[204:205], v21 offset:22528
ds_read_b64_tr_b16 a[206:207], v21 offset:23552
s_add_u32 m0, s41, 94208
v_mfma_f32_32x32x16_bf16 v[48:63], a[220:223], a[156:159], v[48:63]
buffer_load_dwordx4 v9, s[16:19], s15 offen lds
s_waitcnt lgkmcnt(0)
v_mfma_f32_32x32x16_bf16 v[32:47], a[192:195], a[160:163], v[32:47]
ds_read_b64_tr_b16 a[208:209], v20 offset:24576
ds_read_b64_tr_b16 a[210:211], v20 offset:25600
ds_read_b64_tr_b16 a[212:213], v21 offset:24576
v_mfma_f32_32x32x16_bf16 v[48:63], a[196:199], a[160:163], v[48:63]
ds_read_b64_tr_b16 a[214:215], v21 offset:25600
ds_read_b64_tr_b16 a[216:217], v20 offset:26624
ds_read_b64_tr_b16 a[218:219], v20 offset:27648
s_add_u32 m0, s41, 98304
v_mfma_f32_32x32x16_bf16 v[32:47], a[200:203], a[164:167], v[32:47]
buffer_load_dwordx4 v11, s[16:19], s15 offen lds
ds_read_b64_tr_b16 a[220:221], v21 offset:26624
ds_read_b64_tr_b16 a[222:223], v21 offset:27648
s_add_u32 s16, s16, 1384448
s_addc_u32 s17, s17, 0
s_sub_u32 s18, s18, 1384448
v_add_u32 v8, v223, v8
v_add_u32 v9, v223, v9
v_add_u32 v10, v223, v10
v_add_u32 v11, v223, v11
s_add_u32 m0, s41, 102400
v_mfma_f32_32x32x16_bf16 v[48:63], a[204:207], a[164:167], v[48:63]
buffer_load_dwordx4 v8, s[16:19], s50 offen lds
s_waitcnt lgkmcnt(0)
v_mfma_f32_32x32x16_bf16 v[32:47], a[208:211], a[168:171], v[32:47]
ds_read_b64_tr_b16 a[192:193], v20 offset:28672
ds_read_b64_tr_b16 a[194:195], v20 offset:29696
ds_read_b64_tr_b16 a[196:197], v21 offset:28672
v_mfma_f32_32x32x16_bf16 v[48:63], a[212:215], a[168:171], v[48:63]
ds_read_b64_tr_b16 a[198:199], v21 offset:29696
ds_read_b64_tr_b16 a[200:201], v20 offset:30720
ds_read_b64_tr_b16 a[202:203], v20 offset:31744
s_add_u32 m0, s41, 106496
v_mfma_f32_32x32x16_bf16 v[32:47], a[216:219], a[172:175], v[32:47]
buffer_load_dwordx4 v10, s[16:19], s50 offen lds
ds_read_b64_tr_b16 a[204:205], v21 offset:30720
ds_read_b64_tr_b16 a[206:207], v21 offset:31744
s_add_u32 m0, s41, 0
v_mfma_f32_32x32x16_bf16 v[48:63], a[220:223], a[172:175], v[48:63]
buffer_load_dwordx4 v8, s[16:19], s57 offen lds
s_waitcnt lgkmcnt(0)
v_mfma_f32_32x32x16_bf16 v[64:79], a[192:195], a[48:51], v[64:79]
ds_read_b64_tr_b16 a[208:209], v20 offset:32768
ds_read_b64_tr_b16 a[210:211], v20 offset:33792
ds_read_b64_tr_b16 a[212:213], v21 offset:32768
v_mfma_f32_32x32x16_bf16 v[80:95], a[196:199], a[48:51], v[80:95]
ds_read_b64_tr_b16 a[214:215], v21 offset:33792
ds_read_b64_tr_b16 a[216:217], v20 offset:34816
ds_read_b64_tr_b16 a[218:219], v20 offset:35840
v_mul_f32 v32, v96, v32
v_mul_f32 v33, v97, v33
v_cvt_pk_bf16_f32 v160, v32, v33
v_mfma_f32_32x32x16_bf16 v[64:79], a[200:203], a[52:55], v[64:79]
ds_read_b64_tr_b16 a[220:221], v21 offset:34816
ds_read_b64_tr_b16 a[222:223], v21 offset:35840
v_mul_f32 v34, v98, v34
v_mul_f32 v35, v99, v35
v_cvt_pk_bf16_f32 v161, v34, v35
v_mul_f32 v36, v100, v36
v_mfma_f32_32x32x16_bf16 v[80:95], a[204:207], a[52:55], v[80:95]
v_mul_f32 v37, v101, v37
v_cvt_pk_bf16_f32 v162, v36, v37
v_mul_f32 v38, v102, v38
v_mul_f32 v39, v103, v39
v_cvt_pk_bf16_f32 v163, v38, v39
s_waitcnt vmcnt(13) lgkmcnt(0)
v_mfma_f32_32x32x16_bf16 v[64:79], a[208:211], a[56:59], v[64:79]
s_barrier
ds_read_b64_tr_b16 a[192:193], v20 offset:36864
ds_read_b64_tr_b16 a[194:195], v20 offset:37888
v_mul_f32 v40, v104, v40
v_mfma_f32_32x32x16_bf16 v[80:95], a[212:215], a[56:59], v[80:95]
ds_read_b64_tr_b16 a[196:197], v21 offset:36864
ds_read_b64_tr_b16 a[198:199], v21 offset:37888
ds_read_b64_tr_b16 a[200:201], v20 offset:38912
v_mul_f32 v41, v105, v41
v_cvt_pk_bf16_f32 v164, v40, v41
v_mul_f32 v42, v106, v42
v_mfma_f32_32x32x16_bf16 v[64:79], a[216:219], a[60:63], v[64:79]
s_add_u32 s43, s63, 16777216
buffer_store_dwordx4 v[160:163], v26, s[24:27], s43 offen offset:0 sc1
ds_read_b64_tr_b16 a[202:203], v20 offset:39936
ds_read_b64_tr_b16 a[204:205], v21 offset:38912
ds_read_b64_tr_b16 a[206:207], v21 offset:39936
v_mfma_f32_32x32x16_bf16 v[80:95], a[220:223], a[60:63], v[80:95]
v_mul_f32 v43, v107, v43
v_cvt_pk_bf16_f32 v165, v42, v43
v_mul_f32 v44, v108, v44
v_mul_f32 v45, v109, v45
v_cvt_pk_bf16_f32 v166, v44, v45
s_waitcnt lgkmcnt(0)
v_mfma_f32_32x32x16_bf16 v[64:79], a[192:195], a[64:67], v[64:79]
ds_read_b64_tr_b16 a[208:209], v20 offset:40960
ds_read_b64_tr_b16 a[210:211], v20 offset:41984
ds_read_b64_tr_b16 a[212:213], v21 offset:40960
v_mul_f32 v46, v110, v46
v_mul_f32 v47, v111, v47
v_cvt_pk_bf16_f32 v167, v46, v47
v_mfma_f32_32x32x16_bf16 v[80:95], a[196:199], a[64:67], v[80:95]
ds_read_b64_tr_b16 a[214:215], v21 offset:41984
ds_read_b64_tr_b16 a[216:217], v20 offset:43008
ds_read_b64_tr_b16 a[218:219], v20 offset:44032
v_mul_f32 v48, v112, v48
v_mul_f32 v49, v113, v49
v_cvt_pk_bf16_f32 v168, v48, v49
v_mfma_f32_32x32x16_bf16 v[64:79], a[200:203], a[68:71], v[64:79]
buffer_store_dwordx4 v[164:167], v26, s[24:27], s43 offen offset:1024 sc1
ds_read_b64_tr_b16 a[220:221], v21 offset:43008
ds_read_b64_tr_b16 a[222:223], v21 offset:44032
v_mfma_f32_32x32x16_bf16 v[80:95], a[204:207], a[68:71], v[80:95]
v_mul_f32 v50, v114, v50
v_mul_f32 v51, v115, v51
v_cvt_pk_bf16_f32 v169, v50, v51
v_mul_f32 v52, v116, v52
v_mul_f32 v53, v117, v53
s_waitcnt lgkmcnt(0)
v_mfma_f32_32x32x16_bf16 v[64:79], a[208:211], a[72:75], v[64:79]
ds_read_b64_tr_b16 a[192:193], v20 offset:45056
ds_read_b64_tr_b16 a[194:195], v20 offset:46080
ds_read_b64_tr_b16 a[196:197], v21 offset:45056
v_cvt_pk_bf16_f32 v170, v52, v53
v_mul_f32 v54, v118, v54
v_mul_f32 v55, v119, v55
v_mfma_f32_32x32x16_bf16 v[80:95], a[212:215], a[72:75], v[80:95]
ds_read_b64_tr_b16 a[198:199], v21 offset:46080
ds_read_b64_tr_b16 a[200:201], v20 offset:47104
ds_read_b64_tr_b16 a[202:203], v20 offset:48128
v_cvt_pk_bf16_f32 v171, v54, v55
v_mul_f32 v56, v120, v56
v_mul_f32 v57, v121, v57
v_mfma_f32_32x32x16_bf16 v[64:79], a[216:219], a[76:79], v[64:79]
ds_read_b64_tr_b16 a[204:205], v21 offset:47104
ds_read_b64_tr_b16 a[206:207], v21 offset:48128
v_cvt_pk_bf16_f32 v172, v56, v57
v_mul_f32 v58, v122, v58
v_mul_f32 v59, v123, v59
v_cvt_pk_bf16_f32 v173, v58, v59
v_mfma_f32_32x32x16_bf16 v[80:95], a[220:223], a[76:79], v[80:95]
buffer_store_dwordx4 v[168:171], v26, s[24:27], s43 offen offset:2048 sc1
v_mul_f32 v60, v124, v60
s_waitcnt lgkmcnt(0)
v_mfma_f32_32x32x16_bf16 v[64:79], a[192:195], a[80:83], v[64:79]
ds_read_b64_tr_b16 a[208:209], v20 offset:49152
ds_read_b64_tr_b16 a[210:211], v20 offset:50176
ds_read_b64_tr_b16 a[212:213], v21 offset:49152
v_mul_f32 v61, v125, v61
v_cvt_pk_bf16_f32 v174, v60, v61
v_mul_f32 v62, v126, v62
v_mfma_f32_32x32x16_bf16 v[80:95], a[196:199], a[80:83], v[80:95]
ds_read_b64_tr_b16 a[214:215], v21 offset:50176
ds_read_b64_tr_b16 a[216:217], v20 offset:51200
ds_read_b64_tr_b16 a[218:219], v20 offset:52224
v_mul_f32 v63, v127, v63
v_cvt_pk_bf16_f32 v175, v62, v63
v_mfma_f32_32x32x16_bf16 v[64:79], a[200:203], a[84:87], v[64:79]
ds_read_b64_tr_b16 a[220:221], v21 offset:51200
ds_read_b64_tr_b16 a[222:223], v21 offset:52224
v_mfma_f32_32x32x16_bf16 v[80:95], a[204:207], a[84:87], v[80:95]
buffer_store_dwordx4 v[172:175], v26, s[24:27], s43 offen offset:3072 sc1
s_waitcnt lgkmcnt(0)
v_mfma_f32_32x32x16_bf16 v[64:79], a[208:211], a[88:91], v[64:79]
ds_read_b64_tr_b16 a[192:193], v20 offset:53248
ds_read_b64_tr_b16 a[194:195], v20 offset:54272
ds_read_b64_tr_b16 a[196:197], v21 offset:53248
v_mfma_f32_32x32x16_bf16 v[80:95], a[212:215], a[88:91], v[80:95]
ds_read_b64_tr_b16 a[198:199], v21 offset:54272
ds_read_b64_tr_b16 a[200:201], v20 offset:55296
ds_read_b64_tr_b16 a[202:203], v20 offset:56320
s_add_u32 m0, s41, 4096
v_mfma_f32_32x32x16_bf16 v[64:79], a[216:219], a[92:95], v[64:79]
buffer_load_dwordx4 v10, s[16:19], s57 offen lds
ds_read_b64_tr_b16 a[204:205], v21 offset:55296
ds_read_b64_tr_b16 a[206:207], v21 offset:56320
s_add_u32 m0, s41, 8192
v_mfma_f32_32x32x16_bf16 v[80:95], a[220:223], a[92:95], v[80:95]
buffer_load_dwordx4 v9, s[16:19], s50 offen lds
s_waitcnt lgkmcnt(0)
v_mfma_f32_32x32x16_bf16 v[64:79], a[192:195], v[176:179], v[64:79]
ds_read_b64_tr_b16 a[208:209], v20 offset:57344
ds_read_b64_tr_b16 a[210:211], v20 offset:58368
ds_read_b64_tr_b16 a[212:213], v21 offset:57344
v_mfma_f32_32x32x16_bf16 v[80:95], a[196:199], v[176:179], v[80:95]
ds_read_b64_tr_b16 a[214:215], v21 offset:58368
ds_read_b64_tr_b16 a[216:217], v20 offset:59392
ds_read_b64_tr_b16 a[218:219], v20 offset:60416
s_add_u32 m0, s41, 12288
v_mfma_f32_32x32x16_bf16 v[64:79], a[200:203], v[180:183], v[64:79]
buffer_load_dwordx4 v11, s[16:19], s50 offen lds
ds_read_b64_tr_b16 a[220:221], v21 offset:59392
ds_read_b64_tr_b16 a[222:223], v21 offset:60416
s_add_u32 m0, s41, 16384
v_mfma_f32_32x32x16_bf16 v[80:95], a[204:207], v[180:183], v[80:95]
buffer_load_dwordx4 v9, s[16:19], s57 offen lds
s_waitcnt vmcnt(15) lgkmcnt(0)
v_mfma_f32_32x32x16_bf16 v[64:79], a[208:211], v[184:187], v[64:79]
s_barrier
ds_read_b64_tr_b16 a[192:193], v20 offset:61440
ds_read_b64_tr_b16 a[194:195], v20 offset:62464
v_mfma_f32_32x32x16_bf16 v[80:95], a[212:215], v[184:187], v[80:95]
ds_read_b64_tr_b16 a[196:197], v21 offset:61440
ds_read_b64_tr_b16 a[198:199], v21 offset:62464
ds_read_b64_tr_b16 a[200:201], v20 offset:63488
s_add_u32 m0, s41, 20480
v_mfma_f32_32x32x16_bf16 v[64:79], a[216:219], v[188:191], v[64:79]
buffer_load_dwordx4 v11, s[16:19], s57 offen lds
ds_read_b64_tr_b16 a[202:203], v20 offset:64512
ds_read_b64_tr_b16 a[204:205], v21 offset:63488
ds_read_b64_tr_b16 a[206:207], v21 offset:64512
s_add_u32 m0, s41, 24576
v_mfma_f32_32x32x16_bf16 v[80:95], a[220:223], v[188:191], v[80:95]
buffer_load_dwordx4 v8, s[16:19], s51 offen lds
v_permlane32_swap_b32 v176, v178
s_waitcnt lgkmcnt(0)
v_mfma_f32_32x32x16_bf16 v[64:79], a[192:195], a[96:99], v[64:79]
ds_read_b64_tr_b16 a[208:209], v22 offset:0
ds_read_b64_tr_b16 a[210:211], v22 offset:1024
ds_read_b64_tr_b16 a[212:213], v23 offset:0
v_permlane32_swap_b32 v177, v179
v_lshlrev_b32 v128, 16, v176
v_mfma_f32_32x32x16_bf16 v[80:95], a[196:199], a[96:99], v[80:95]
ds_read_b64_tr_b16 a[214:215], v23 offset:1024
ds_read_b64_tr_b16 a[216:217], v22 offset:2048
ds_read_b64_tr_b16 a[218:219], v22 offset:3072
v_and_b32 v129, 0xffff0000, v176
s_add_u32 m0, s41, 28672
v_mfma_f32_32x32x16_bf16 v[64:79], a[200:203], a[100:103], v[64:79]
buffer_load_dwordx4 v10, s[16:19], s51 offen lds
ds_read_b64_tr_b16 a[220:221], v23 offset:2048
ds_read_b64_tr_b16 a[222:223], v23 offset:3072
v_lshlrev_b32 v130, 16, v177
s_add_u32 m0, s41, 114688
v_mfma_f32_32x32x16_bf16 v[80:95], a[204:207], a[100:103], v[80:95]
buffer_load_dwordx4 v8, s[16:19], s52 offen lds
v_and_b32 v131, 0xffff0000, v177
s_waitcnt lgkmcnt(0)
v_mfma_f32_32x32x16_bf16 v[64:79], a[208:211], a[104:107], v[64:79]
ds_read_b64_tr_b16 a[192:193], v22 offset:4096
ds_read_b64_tr_b16 a[194:195], v22 offset:5120
ds_read_b64_tr_b16 a[196:197], v23 offset:4096
v_lshlrev_b32 v132, 16, v178
v_and_b32 v133, 0xffff0000, v178
v_mfma_f32_32x32x16_bf16 v[80:95], a[212:215], a[104:107], v[80:95]
ds_read_b64_tr_b16 a[198:199], v23 offset:5120
ds_read_b64_tr_b16 a[200:201], v22 offset:6144
ds_read_b64_tr_b16 a[202:203], v22 offset:7168
v_lshlrev_b32 v134, 16, v179
s_add_u32 m0, s41, 118784
v_mfma_f32_32x32x16_bf16 v[64:79], a[216:219], a[108:111], v[64:79]
buffer_load_dwordx4 v10, s[16:19], s52 offen lds
ds_read_b64_tr_b16 a[204:205], v23 offset:6144
ds_read_b64_tr_b16 a[206:207], v23 offset:7168
v_and_b32 v135, 0xffff0000, v179
v_permlane32_swap_b32 v180, v182
s_add_u32 m0, s41, 126976
v_mfma_f32_32x32x16_bf16 v[80:95], a[220:223], a[108:111], v[80:95]
buffer_load_dwordx4 v8, s[16:19], s53 offen lds
v_permlane32_swap_b32 v181, v183
s_waitcnt lgkmcnt(0)
v_mfma_f32_32x32x16_bf16 v[64:79], a[192:195], a[112:115], v[64:79]
ds_read_b64_tr_b16 a[208:209], v22 offset:8192
ds_read_b64_tr_b16 a[210:211], v22 offset:9216
ds_read_b64_tr_b16 a[212:213], v23 offset:8192
v_lshlrev_b32 v136, 16, v180
ds_read_b128 v[224:227], v29 offset:512
ds_read_b128 v[228:231], v29 offset:544
v_mfma_f32_32x32x16_bf16 v[80:95], a[196:199], a[112:115], v[80:95]
ds_read_b64_tr_b16 a[214:215], v23 offset:9216
ds_read_b64_tr_b16 a[216:217], v22 offset:10240
ds_read_b64_tr_b16 a[218:219], v22 offset:11264
v_and_b32 v137, 0xffff0000, v180
ds_read_b128 v[232:235], v29 offset:576
s_add_u32 m0, s41, 131072
v_mfma_f32_32x32x16_bf16 v[64:79], a[200:203], a[116:119], v[64:79]
buffer_load_dwordx4 v10, s[16:19], s53 offen lds
ds_read_b64_tr_b16 a[220:221], v23 offset:10240
ds_read_b64_tr_b16 a[222:223], v23 offset:11264
v_lshlrev_b32 v138, 16, v181
s_add_u32 m0, s41, 139264
v_mfma_f32_32x32x16_bf16 v[80:95], a[204:207], a[116:119], v[80:95]
buffer_load_dwordx4 v8, s[16:19], s54 offen lds
v_and_b32 v139, 0xffff0000, v181
s_waitcnt lgkmcnt(0)
v_mfma_f32_32x32x16_bf16 v[64:79], a[208:211], a[120:123], v[64:79]
ds_read_b64_tr_b16 a[192:193], v22 offset:12288
ds_read_b64_tr_b16 a[194:195], v22 offset:13312
ds_read_b64_tr_b16 a[196:197], v23 offset:12288
v_lshlrev_b32 v140, 16, v182
ds_read_b128 v[236:239], v29 offset:608
ds_read_b128 v[240:243], v29 offset:640
v_mfma_f32_32x32x16_bf16 v[80:95], a[212:215], a[120:123], v[80:95]
ds_read_b64_tr_b16 a[198:199], v23 offset:13312
ds_read_b64_tr_b16 a[200:201], v22 offset:14336
ds_read_b64_tr_b16 a[202:203], v22 offset:15360
v_and_b32 v141, 0xffff0000, v182
ds_read_b128 v[244:247], v29 offset:672
s_add_u32 m0, s41, 143360
v_mfma_f32_32x32x16_bf16 v[64:79], a[216:219], a[124:127], v[64:79]
buffer_load_dwordx4 v10, s[16:19], s54 offen lds
ds_read_b64_tr_b16 a[204:205], v23 offset:14336
ds_read_b64_tr_b16 a[206:207], v23 offset:15360
v_lshlrev_b32 v142, 16, v183
s_add_u32 m0, s41, 151552
v_mfma_f32_32x32x16_bf16 v[80:95], a[220:223], a[124:127], v[80:95]
buffer_load_dwordx4 v8, s[16:19], s55 offen lds
v_and_b32 v143, 0xffff0000, v183
s_waitcnt lgkmcnt(0)
v_mfma_f32_32x32x16_bf16 v[64:79], a[192:195], a[128:131], v[64:79]
ds_read_b64_tr_b16 a[208:209], v22 offset:16384
ds_read_b64_tr_b16 a[210:211], v22 offset:17408
ds_read_b64_tr_b16 a[212:213], v23 offset:16384
v_permlane32_swap_b32 v184, v186
ds_read_b128 v[248:251], v29 offset:704
ds_read_b128 v[252:255], v29 offset:736
v_mfma_f32_32x32x16_bf16 v[80:95], a[196:199], a[128:131], v[80:95]
ds_read_b64_tr_b16 a[214:215], v23 offset:17408
ds_read_b64_tr_b16 a[216:217], v22 offset:18432
ds_read_b64_tr_b16 a[218:219], v22 offset:19456
v_permlane32_swap_b32 v185, v187
v_lshlrev_b32 v144, 16, v184
v_mfma_f32_32x32x16_bf16 v[64:79], a[200:203], a[132:135], v[64:79]
s_waitcnt vmcnt(14)
s_mov_b32 s44, 0
s_cmp_lg_u32 s32, 0
s_cbranch_scc0 L_mr_fl0x
buffer_store_dwordx2 v[6:7], v31, s[24:27], s44 offen
L_mr_fl0j:
ds_read_b64_tr_b16 a[220:221], v23 offset:18432
ds_read_b64_tr_b16 a[222:223], v23 offset:19456
s_add_u32 m0, s41, 155648
v_mfma_f32_32x32x16_bf16 v[80:95], a[204:207], a[132:135], v[80:95]
buffer_load_dwordx4 v10, s[16:19], s55 offen lds
v_and_b32 v145, 0xffff0000, v184
s_waitcnt lgkmcnt(0)
v_mfma_f32_32x32x16_bf16 v[64:79], a[208:211], a[136:139], v[64:79]
s_barrier
ds_read_b64_tr_b16 a[192:193], v22 offset:20480
ds_read_b64_tr_b16 a[194:195], v22 offset:21504
v_lshlrev_b32 v146, 16, v185
v_mfma_f32_32x32x16_bf16 v[80:95], a[212:215], a[136:139], v[80:95]
ds_read_b64_tr_b16 a[196:197], v23 offset:20480
ds_read_b64_tr_b16 a[198:199], v23 offset:21504
ds_read_b64_tr_b16 a[200:201], v22 offset:22528
v_and_b32 v147, 0xffff0000, v185
s_add_u32 m0, s41, 32768
v_mfma_f32_32x32x16_bf16 v[64:79], a[216:219], a[140:143], v[64:79]
buffer_load_dwordx4 v8, s[16:19], s56 offen lds
ds_read_b64_tr_b16 a[202:203], v22 offset:23552
ds_read_b64_tr_b16 a[204:205], v23 offset:22528
ds_read_b64_tr_b16 a[206:207], v23 offset:23552
v_lshlrev_b32 v148, 16, v186
s_add_u32 m0, s41, 36864
v_mfma_f32_32x32x16_bf16 v[80:95], a[220:223], a[140:143], v[80:95]
buffer_load_dwordx4 v10, s[16:19], s56 offen lds
v_and_b32 v149, 0xffff0000, v186
s_waitcnt lgkmcnt(0)
v_mfma_f32_32x32x16_bf16 v[64:79], a[192:195], a[144:147], v[64:79]
ds_read_b64_tr_b16 a[208:209], v22 offset:24576
ds_read_b64_tr_b16 a[210:211], v22 offset:25600
ds_read_b64_tr_b16 a[212:213], v23 offset:24576
v_lshlrev_b32 v150, 16, v187
v_and_b32 v151, 0xffff0000, v187
v_mfma_f32_32x32x16_bf16 v[80:95], a[196:199], a[144:147], v[80:95]
ds_read_b64_tr_b16 a[214:215], v23 offset:25600
ds_read_b64_tr_b16 a[216:217], v22 offset:26624
ds_read_b64_tr_b16 a[218:219], v22 offset:27648
v_permlane32_swap_b32 v188, v190
s_add_u32 m0, s41, 40960
v_mfma_f32_32x32x16_bf16 v[64:79], a[200:203], a[148:151], v[64:79]
buffer_load_dwordx4 v9, s[16:19], s51 offen lds
ds_read_b64_tr_b16 a[220:221], v23 offset:26624
ds_read_b64_tr_b16 a[222:223], v23 offset:27648
v_permlane32_swap_b32 v189, v191
s_add_u32 m0, s41, 45056
v_mfma_f32_32x32x16_bf16 v[80:95], a[204:207], a[148:151], v[80:95]
buffer_load_dwordx4 v11, s[16:19], s51 offen lds
v_lshlrev_b32 v152, 16, v188
s_waitcnt lgkmcnt(0)
v_mfma_f32_32x32x16_bf16 v[64:79], a[208:211], a[152:155], v[64:79]
ds_read_b64_tr_b16 a[192:193], v22 offset:28672
ds_read_b64_tr_b16 a[194:195], v22 offset:29696
ds_read_b64_tr_b16 a[196:197], v23 offset:28672
v_and_b32 v153, 0xffff0000, v188
v_lshlrev_b32 v154, 16, v189
v_mfma_f32_32x32x16_bf16 v[80:95], a[212:215], a[152:155], v[80:95]
ds_read_b64_tr_b16 a[198:199], v23 offset:29696
ds_read_b64_tr_b16 a[200:201], v22 offset:30720
ds_read_b64_tr_b16 a[202:203], v22 offset:31744
v_and_b32 v155, 0xffff0000, v189
s_add_u32 m0, s41, 49152
v_mfma_f32_32x32x16_bf16 v[64:79], a[216:219], a[156:159], v[64:79]
buffer_load_dwordx4 v9, s[16:19], s52 offen lds
ds_read_b64_tr_b16 a[204:205], v23 offset:30720
ds_read_b64_tr_b16 a[206:207], v23 offset:31744
s_add_u32 m0, s41, 53248
v_mfma_f32_32x32x16_bf16 v[80:95], a[220:223], a[156:159], v[80:95]
buffer_load_dwordx4 v11, s[16:19], s52 offen lds
v_lshlrev_b32 v156, 16, v190
s_waitcnt lgkmcnt(0)
v_mfma_f32_32x32x16_bf16 v[64:79], a[192:195], a[160:163], v[64:79]
ds_read_b64_tr_b16 a[208:209], v22 offset:32768
ds_read_b64_tr_b16 a[210:211], v22 offset:33792
ds_read_b64_tr_b16 a[212:213], v23 offset:32768
v_and_b32 v157, 0xffff0000, v190
v_lshlrev_b32 v158, 16, v191
v_mfma_f32_32x32x16_bf16 v[80:95], a[196:199], a[160:163], v[80:95]
ds_read_b64_tr_b16 a[214:215], v23 offset:33792
ds_read_b64_tr_b16 a[216:217], v22 offset:34816
ds_read_b64_tr_b16 a[218:219], v22 offset:35840
v_and_b32 v159, 0xffff0000, v191
s_add_u32 m0, s41, 57344
v_mfma_f32_32x32x16_bf16 v[64:79], a[200:203], a[164:167], v[64:79]
buffer_load_dwordx4 v9, s[16:19], s53 offen lds
ds_read_b64_tr_b16 a[220:221], v23 offset:34816
ds_read_b64_tr_b16 a[222:223], v23 offset:35840
s_add_u32 m0, s41, 61440
v_mfma_f32_32x32x16_bf16 v[80:95], a[204:207], a[164:167], v[80:95]
buffer_load_dwordx4 v11, s[16:19], s53 offen lds
s_waitcnt lgkmcnt(0)
v_mfma_f32_32x32x16_bf16 v[64:79], a[208:211], a[168:171], v[64:79]
ds_read_b64_tr_b16 a[192:193], v22 offset:36864
ds_read_b64_tr_b16 a[194:195], v22 offset:37888
ds_read_b64_tr_b16 a[196:197], v23 offset:36864
v_mfma_f32_32x32x16_bf16 v[80:95], a[212:215], a[168:171], v[80:95]
ds_read_b64_tr_b16 a[198:199], v23 offset:37888
ds_read_b64_tr_b16 a[200:201], v22 offset:38912
ds_read_b64_tr_b16 a[202:203], v22 offset:39936
s_add_u32 m0, s41, 65536
v_mfma_f32_32x32x16_bf16 v[64:79], a[216:219], a[172:175], v[64:79]
buffer_load_dwordx4 v8, s[16:19], s58 offen lds
ds_read_b64_tr_b16 a[204:205], v23 offset:38912
ds_read_b64_tr_b16 a[206:207], v23 offset:39936
s_add_u32 m0, s41, 69632
v_mfma_f32_32x32x16_bf16 v[80:95], a[220:223], a[172:175], v[80:95]
buffer_load_dwordx4 v10, s[16:19], s58 offen lds
s_waitcnt lgkmcnt(0)
v_mfma_f32_32x32x16_bf16 v[32:47], a[192:195], v[160:163], v[224:239]
ds_read_b64_tr_b16 a[208:209], v22 offset:40960
ds_read_b64_tr_b16 a[210:211], v22 offset:41984
ds_read_b64_tr_b16 a[212:213], v23 offset:40960
v_mfma_f32_32x32x16_bf16 v[48:63], a[196:199], v[160:163], v[240:255]
ds_read_b64_tr_b16 a[214:215], v23 offset:41984
ds_read_b64_tr_b16 a[216:217], v22 offset:43008
ds_read_b64_tr_b16 a[218:219], v22 offset:44032
v_mul_f32 v64, v128, v64
v_mul_f32 v65, v129, v65
v_cvt_pk_bf16_f32 v176, v64, v65
v_mfma_f32_32x32x16_bf16 v[32:47], a[200:203], v[164:167], v[32:47]
ds_read_b64_tr_b16 a[220:221], v23 offset:43008
ds_read_b64_tr_b16 a[222:223], v23 offset:44032
v_mul_f32 v66, v130, v66
v_mul_f32 v67, v131, v67
v_cvt_pk_bf16_f32 v177, v66, v67
v_mul_f32 v68, v132, v68
v_mfma_f32_32x32x16_bf16 v[48:63], a[204:207], v[164:167], v[48:63]
ds_read_b128 v[224:227], v29 offset:768
ds_read_b128 v[228:231], v29 offset:800
v_mul_f32 v69, v133, v69
v_cvt_pk_bf16_f32 v178, v68, v69
v_mul_f32 v70, v134, v70
s_waitcnt vmcnt(21) lgkmcnt(2)
v_mfma_f32_32x32x16_bf16 v[32:47], a[208:211], v[168:171], v[32:47]
s_barrier
ds_read_b64_tr_b16 a[192:193], v20 offset:0
ds_read_b64_tr_b16 a[194:195], v20 offset:1024
ds_read_b128 v[232:235], v29 offset:832
v_mfma_f32_32x32x16_bf16 v[48:63], a[212:215], v[168:171], v[48:63]
ds_read_b64_tr_b16 a[196:197], v21 offset:0
ds_read_b64_tr_b16 a[198:199], v21 offset:1024
ds_read_b64_tr_b16 a[200:201], v20 offset:2048
ds_read_b128 v[236:239], v29 offset:864
ds_read_b128 v[240:243], v29 offset:896
v_mul_f32 v71, v135, v71
v_mfma_f32_32x32x16_bf16 v[32:47], a[216:219], v[172:175], v[32:47]
s_mov_b32 s45, 0
buffer_load_dwordx2 v[0:1], v30, s[24:27], s45 offen sc1
ds_read_b64_tr_b16 a[202:203], v20 offset:3072
ds_read_b64_tr_b16 a[204:205], v21 offset:2048
ds_read_b64_tr_b16 a[206:207], v21 offset:3072
v_mfma_f32_32x32x16_bf16 v[48:63], a[220:223], v[172:175], v[48:63]
ds_read_b128 v[244:247], v29 offset:928
ds_read_b128 v[248:251], v29 offset:960
v_cvt_pk_bf16_f32 v179, v70, v71
v_mul_f32 v72, v136, v72
v_mul_f32 v73, v137, v73
v_cvt_pk_bf16_f32 v180, v72, v73
v_mul_f32 v74, v138, v74
v_mul_f32 v75, v139, v75
v_cvt_pk_bf16_f32 v181, v74, v75
v_mul_f32 v76, v140, v76
v_mul_f32 v77, v141, v77
v_cvt_pk_bf16_f32 v182, v76, v77
v_mul_f32 v78, v142, v78
v_mul_f32 v79, v143, v79
v_cvt_pk_bf16_f32 v183, v78, v79
s_waitcnt lgkmcnt(2)
v_mfma_f32_32x32x16_bf16 v[32:47], a[192:195], v[176:179], v[32:47]
ds_read_b64_tr_b16 a[208:209], v20 offset:4096
ds_read_b64_tr_b16 a[210:211], v20 offset:5120
ds_read_b64_tr_b16 a[212:213], v21 offset:4096
ds_read_b128 v[252:255], v29 offset:992
v_mul_f32 v80, v144, v80
v_mul_f32 v81, v145, v81
v_mfma_f32_32x32x16_bf16 v[48:63], a[196:199], v[176:179], v[48:63]
ds_read_b64_tr_b16 a[214:215], v21 offset:5120
ds_read_b64_tr_b16 a[216:217], v20 offset:6144
ds_read_b64_tr_b16 a[218:219], v20 offset:7168
v_cvt_pk_bf16_f32 v184, v80, v81
v_mul_f32 v82, v146, v82
v_mul_f32 v83, v147, v83
v_mfma_f32_32x32x16_bf16 v[32:47], a[200:203], v[180:183], v[32:47]
s_add_u32 s43, s70, 16777216
buffer_store_dwordx4 v[176:179], v26, s[24:27], s43 offen offset:0 sc1
ds_read_b64_tr_b16 a[220:221], v21 offset:6144
ds_read_b64_tr_b16 a[222:223], v21 offset:7168
v_mfma_f32_32x32x16_bf16 v[48:63], a[204:207], v[180:183], v[48:63]
buffer_store_dwordx4 v[180:183], v26, s[24:27], s43 offen offset:1024 sc1
v_cvt_pk_bf16_f32 v185, v82, v83
v_mul_f32 v84, v148, v84
v_mul_f32 v85, v149, v85
v_cvt_pk_bf16_f32 v186, v84, v85
v_mul_f32 v86, v150, v86
v_mul_f32 v87, v151, v87
v_cvt_pk_bf16_f32 v187, v86, v87
v_mul_f32 v88, v152, v88
v_mul_f32 v89, v153, v89
v_cvt_pk_bf16_f32 v188, v88, v89
v_mul_f32 v90, v154, v90
v_mul_f32 v91, v155, v91
v_cvt_pk_bf16_f32 v189, v90, v91
v_mul_f32 v92, v156, v92
v_mul_f32 v93, v157, v93
v_cvt_pk_bf16_f32 v190, v92, v93
v_mul_f32 v94, v158, v94
v_mul_f32 v95, v159, v95
v_cvt_pk_bf16_f32 v191, v94, v95
s_waitcnt lgkmcnt(0)
v_mfma_f32_32x32x16_bf16 v[32:47], a[208:211], v[184:187], v[32:47]
ds_read_b64_tr_b16 a[192:193], v20 offset:8192
ds_read_b64_tr_b16 a[194:195], v20 offset:9216
ds_read_b64_tr_b16 a[196:197], v21 offset:8192
v_lshlrev_b32 v192, 16, v160
v_and_b32 v193, 0xffff0000, v160
v_mfma_f32_32x32x16_bf16 v[48:63], a[212:215], v[184:187], v[48:63]
ds_read_b64_tr_b16 a[198:199], v21 offset:9216
ds_read_b64_tr_b16 a[200:201], v20 offset:10240
ds_read_b64_tr_b16 a[202:203], v20 offset:11264
v_lshlrev_b32 v194, 16, v161
v_and_b32 v195, 0xffff0000, v161
v_mfma_f32_32x32x16_bf16 v[32:47], a[216:219], v[188:191], v[32:47]
buffer_store_dwordx4 v[184:187], v26, s[24:27], s43 offen offset:2048 sc1
ds_read_b64_tr_b16 a[204:205], v21 offset:10240
ds_read_b64_tr_b16 a[206:207], v21 offset:11264
v_mfma_f32_32x32x16_bf16 v[48:63], a[220:223], v[188:191], v[48:63]
buffer_store_dwordx4 v[188:191], v26, s[24:27], s43 offen offset:3072 sc1
s_waitcnt lgkmcnt(0)
v_mfma_f32_32x32x16_bf16 v[64:79], a[192:195], v[160:163], v[224:239]
ds_read_b64_tr_b16 a[208:209], v20 offset:12288
ds_read_b64_tr_b16 a[210:211], v20 offset:13312
ds_read_b64_tr_b16 a[212:213], v21 offset:12288
s_waitcnt vmcnt(4)
L_mr_sp00:
v_cmp_eq_u64 vcc, s[48:49], v[0:1]
s_nop 1
s_and_b32 s44, vcc_lo, 127
s_cmp_eq_u32 s44, 127
s_cbranch_scc0 L_mr_ok00x
L_mr_ok00:
v_mfma_f32_32x32x16_bf16 v[80:95], a[196:199], v[160:163], v[240:255]
ds_read_b64_tr_b16 a[214:215], v21 offset:13312
ds_read_b64_tr_b16 a[216:217], v20 offset:14336
ds_read_b64_tr_b16 a[218:219], v20 offset:15360
v_lshlrev_b32 v196, 16, v162
v_and_b32 v197, 0xffff0000, v162
v_mfma_f32_32x32x16_bf16 v[64:79], a[200:203], v[164:167], v[64:79]
buffer_load_dwordx4 a[0:3], v26, s[76:79], s64 offen offset:0 sc1
ds_read_b64_tr_b16 a[220:221], v21 offset:14336
ds_read_b64_tr_b16 a[222:223], v21 offset:15360
v_mfma_f32_32x32x16_bf16 v[80:95], a[204:207], v[164:167], v[80:95]
buffer_load_dwordx4 a[4:7], v26, s[76:79], s64 offen offset:1024 sc1
s_waitcnt lgkmcnt(0)
v_mfma_f32_32x32x16_bf16 v[64:79], a[208:211], v[168:171], v[64:79]
ds_read_b64_tr_b16 a[192:193], v20 offset:16384
ds_read_b64_tr_b16 a[194:195], v20 offset:17408
ds_read_b64_tr_b16 a[196:197], v21 offset:16384
v_lshlrev_b32 v198, 16, v163
v_and_b32 v199, 0xffff0000, v163
v_mfma_f32_32x32x16_bf16 v[80:95], a[212:215], v[168:171], v[80:95]
buffer_load_dwordx4 a[8:11], v26, s[76:79], s64 offen offset:2048 sc1
ds_read_b64_tr_b16 a[198:199], v21 offset:17408
ds_read_b64_tr_b16 a[200:201], v20 offset:18432
ds_read_b64_tr_b16 a[202:203], v20 offset:19456
v_mfma_f32_32x32x16_bf16 v[64:79], a[216:219], v[172:175], v[64:79]
buffer_load_dwordx4 a[12:15], v26, s[76:79], s64 offen offset:3072 sc1
ds_read_b64_tr_b16 a[204:205], v21 offset:18432
ds_read_b64_tr_b16 a[206:207], v21 offset:19456
v_mfma_f32_32x32x16_bf16 v[80:95], a[220:223], v[172:175], v[80:95]
buffer_load_dwordx4 a[16:19], v26, s[76:79], s65 offen offset:0 sc1
s_waitcnt lgkmcnt(0)
v_mfma_f32_32x32x16_bf16 v[64:79], a[192:195], v[176:179], v[64:79]
ds_read_b64_tr_b16 a[208:209], v20 offset:20480
ds_read_b64_tr_b16 a[210:211], v20 offset:21504
ds_read_b64_tr_b16 a[212:213], v21 offset:20480
v_lshlrev_b32 v200, 16, v164
v_and_b32 v201, 0xffff0000, v164
v_mfma_f32_32x32x16_bf16 v[80:95], a[196:199], v[176:179], v[80:95]
buffer_load_dwordx4 a[20:23], v26, s[76:79], s65 offen offset:1024 sc1
ds_read_b64_tr_b16 a[214:215], v21 offset:21504
ds_read_b64_tr_b16 a[216:217], v20 offset:22528
ds_read_b64_tr_b16 a[218:219], v20 offset:23552
v_mfma_f32_32x32x16_bf16 v[64:79], a[200:203], v[180:183], v[64:79]
buffer_load_dwordx4 a[24:27], v26, s[76:79], s65 offen offset:2048 sc1
ds_read_b64_tr_b16 a[220:221], v21 offset:22528
ds_read_b64_tr_b16 a[222:223], v21 offset:23552
v_mfma_f32_32x32x16_bf16 v[80:95], a[204:207], v[180:183], v[80:95]
buffer_load_dwordx4 a[28:31], v26, s[76:79], s65 offen offset:3072 sc1
s_waitcnt lgkmcnt(0)
v_mfma_f32_32x32x16_bf16 v[64:79], a[208:211], v[184:187], v[64:79]
s_barrier
ds_read_b64_tr_b16 a[192:193], v20 offset:24576
ds_read_b64_tr_b16 a[194:195], v20 offset:25600
v_mfma_f32_32x32x16_bf16 v[80:95], a[212:215], v[184:187], v[80:95]
buffer_load_dwordx4 a[32:35], v26, s[76:79], s66 offen offset:0 sc1
ds_read_b64_tr_b16 a[196:197], v21 offset:24576
ds_read_b64_tr_b16 a[198:199], v21 offset:25600
ds_read_b64_tr_b16 a[200:201], v20 offset:26624
v_mfma_f32_32x32x16_bf16 v[64:79], a[216:219], v[188:191], v[64:79]
buffer_load_dwordx4 a[36:39], v26, s[76:79], s66 offen offset:1024 sc1
ds_read_b64_tr_b16 a[202:203], v20 offset:27648
ds_read_b64_tr_b16 a[204:205], v21 offset:26624
ds_read_b64_tr_b16 a[206:207], v21 offset:27648
v_mfma_f32_32x32x16_bf16 v[80:95], a[220:223], v[188:191], v[80:95]
buffer_load_dwordx4 a[40:43], v26, s[76:79], s66 offen offset:2048 sc1
s_waitcnt vmcnt(9) lgkmcnt(0)
v_mfma_f32_32x32x16_bf16 v[32:47], a[192:195], a[0:3], v[32:47]
ds_read_b64_tr_b16 a[208:209], v20 offset:28672
ds_read_b64_tr_b16 a[210:211], v20 offset:29696
ds_read_b64_tr_b16 a[212:213], v21 offset:28672
v_lshlrev_b32 v202, 16, v165
v_and_b32 v203, 0xffff0000, v165
v_mfma_f32_32x32x16_bf16 v[48:63], a[196:199], a[0:3], v[48:63]
buffer_load_dwordx4 a[44:47], v26, s[76:79], s66 offen offset:3072 sc1
ds_read_b64_tr_b16 a[214:215], v21 offset:29696
ds_read_b64_tr_b16 a[216:217], v20 offset:30720
ds_read_b64_tr_b16 a[218:219], v20 offset:31744
v_mfma_f32_32x32x16_bf16 v[32:47], a[200:203], a[4:7], v[32:47]
buffer_load_dwordx4 a[48:51], v26, s[76:79], s67 offen offset:0 sc1
ds_read_b64_tr_b16 a[220:221], v21 offset:30720
ds_read_b64_tr_b16 a[222:223], v21 offset:31744
v_mfma_f32_32x32x16_bf16 v[48:63], a[204:207], a[4:7], v[48:63]
buffer_load_dwordx4 a[52:55], v26, s[76:79], s67 offen offset:1024 sc1
s_waitcnt vmcnt(10) lgkmcnt(0)
v_mfma_f32_32x32x16_bf16 v[32:47], a[208:211], a[8:11], v[32:47]
ds_read_b64_tr_b16 a[192:193], v22 offset:49152
ds_read_b64_tr_b16 a[194:195], v22 offset:50176
ds_read_b64_tr_b16 a[196:197], v23 offset:49152
v_lshlrev_b32 v204, 16, v166
v_and_b32 v205, 0xffff0000, v166
v_mfma_f32_32x32x16_bf16 v[48:63], a[212:215], a[8:11], v[48:63]
ds_read_b64_tr_b16 a[198:199], v23 offset:50176
ds_read_b64_tr_b16 a[200:201], v22 offset:51200
ds_read_b64_tr_b16 a[202:203], v22 offset:52224
v_lshlrev_b32 v206, 16, v167
v_and_b32 v207, 0xffff0000, v167
v_mfma_f32_32x32x16_bf16 v[32:47], a[216:219], a[12:15], v[32:47]
buffer_load_dwordx4 a[56:59], v26, s[76:79], s67 offen offset:2048 sc1
ds_read_b64_tr_b16 a[204:205], v23 offset:51200
ds_read_b64_tr_b16 a[206:207], v23 offset:52224
v_mfma_f32_32x32x16_bf16 v[48:63], a[220:223], a[12:15], v[48:63]
buffer_load_dwordx4 a[60:63], v26, s[76:79], s67 offen offset:3072 sc1
s_waitcnt vmcnt(10) lgkmcnt(0)
v_mfma_f32_32x32x16_bf16 v[32:47], a[192:195], a[16:19], v[32:47]
ds_read_b64_tr_b16 a[208:209], v22 offset:53248
ds_read_b64_tr_b16 a[210:211], v22 offset:54272
ds_read_b64_tr_b16 a[212:213], v23 offset:53248
v_lshlrev_b32 v208, 16, v168
v_and_b32 v209, 0xffff0000, v168
v_mfma_f32_32x32x16_bf16 v[48:63], a[196:199], a[16:19], v[48:63]
ds_read_b64_tr_b16 a[214:215], v23 offset:54272
ds_read_b64_tr_b16 a[216:217], v22 offset:55296
ds_read_b64_tr_b16 a[218:219], v22 offset:56320
v_lshlrev_b32 v210, 16, v169
v_and_b32 v211, 0xffff0000, v169
v_mfma_f32_32x32x16_bf16 v[32:47], a[200:203], a[20:23], v[32:47]
buffer_load_dwordx4 a[64:67], v26, s[76:79], s68 offen offset:0 sc1
ds_read_b64_tr_b16 a[220:221], v23 offset:55296
ds_read_b64_tr_b16 a[222:223], v23 offset:56320
v_mfma_f32_32x32x16_bf16 v[48:63], a[204:207], a[20:23], v[48:63]
buffer_load_dwordx4 a[68:71], v26, s[76:79], s68 offen offset:1024 sc1
s_waitcnt vmcnt(10) lgkmcnt(0)
v_mfma_f32_32x32x16_bf16 v[32:47], a[208:211], a[24:27], v[32:47]
ds_read_b64_tr_b16 a[192:193], v22 offset:61440
ds_read_b64_tr_b16 a[194:195], v22 offset:62464
ds_read_b64_tr_b16 a[196:197], v23 offset:61440
v_lshlrev_b32 v212, 16, v170
v_and_b32 v213, 0xffff0000, v170
v_mfma_f32_32x32x16_bf16 v[48:63], a[212:215], a[24:27], v[48:63]
ds_read_b64_tr_b16 a[198:199], v23 offset:62464
ds_read_b64_tr_b16 a[200:201], v22 offset:63488
ds_read_b64_tr_b16 a[202:203], v22 offset:64512
v_lshlrev_b32 v214, 16, v171
v_and_b32 v215, 0xffff0000, v171
v_mfma_f32_32x32x16_bf16 v[32:47], a[216:219], a[28:31], v[32:47]
s_mov_b32 s44, 16384
s_cmp_lg_u32 s32, 0
s_cbranch_scc0 L_mr_fl1x
buffer_store_dwordx2 v[6:7], v31, s[24:27], s44 offen
L_mr_fl1j:
ds_read_b64_tr_b16 a[204:205], v23 offset:63488
ds_read_b64_tr_b16 a[206:207], v23 offset:64512
v_mfma_f32_32x32x16_bf16 v[48:63], a[220:223], a[28:31], v[48:63]
buffer_load_dwordx4 a[72:75], v26, s[76:79], s68 offen offset:2048 sc1
s_waitcnt vmcnt(10) lgkmcnt(0)
v_mfma_f32_32x32x16_bf16 v[32:47], a[192:195], a[32:35], v[32:47]
ds_read_b64_tr_b16 a[208:209], v24 offset:0
ds_read_b64_tr_b16 a[210:211], v24 offset:1024
ds_read_b64_tr_b16 a[212:213], v25 offset:0
v_lshlrev_b32 v216, 16, v172
v_and_b32 v217, 0xffff0000, v172
v_mfma_f32_32x32x16_bf16 v[48:63], a[196:199], a[32:35], v[48:63]
buffer_load_dwordx4 a[76:79], v26, s[76:79], s68 offen offset:3072 sc1
ds_read_b64_tr_b16 a[214:215], v25 offset:1024
ds_read_b64_tr_b16 a[216:217], v24 offset:2048
ds_read_b64_tr_b16 a[218:219], v24 offset:3072
v_mfma_f32_32x32x16_bf16 v[32:47], a[200:203], a[36:39], v[32:47]
buffer_load_dwordx4 a[80:83], v26, s[76:79], s69 offen offset:0 sc1
ds_read_b64_tr_b16 a[220:221], v25 offset:2048
ds_read_b64_tr_b16 a[222:223], v25 offset:3072
v_mfma_f32_32x32x16_bf16 v[48:63], a[204:207], a[36:39], v[48:63]
buffer_load_dwordx4 a[84:87], v26, s[76:79], s69 offen offset:1024 sc1
s_waitcnt vmcnt(11) lgkmcnt(0)
v_mfma_f32_32x32x16_bf16 v[32:47], a[208:211], a[40:43], v[32:47]
s_barrier
ds_read_b64_tr_b16 a[192:193], v24 offset:8192
ds_read_b64_tr_b16 a[194:195], v24 offset:9216
v_mfma_f32_32x32x16_bf16 v[48:63], a[212:215], a[40:43], v[48:63]
ds_read_b64_tr_b16 a[196:197], v25 offset:8192
ds_read_b64_tr_b16 a[198:199], v25 offset:9216
ds_read_b64_tr_b16 a[200:201], v24 offset:10240
v_lshlrev_b32 v218, 16, v173
v_and_b32 v219, 0xffff0000, v173
v_mfma_f32_32x32x16_bf16 v[32:47], a[216:219], a[44:47], v[32:47]
buffer_load_dwordx4 a[88:91], v26, s[76:79], s69 offen offset:2048 sc1
ds_read_b64_tr_b16 a[202:203], v24 offset:11264
ds_read_b64_tr_b16 a[204:205], v25 offset:10240
ds_read_b64_tr_b16 a[206:207], v25 offset:11264
v_mfma_f32_32x32x16_bf16 v[48:63], a[220:223], a[44:47], v[48:63]
buffer_load_dwordx4 a[92:95], v26, s[76:79], s69 offen offset:3072 sc1
s_waitcnt vmcnt(11) lgkmcnt(0)
v_mfma_f32_32x32x16_bf16 v[32:47], a[192:195], a[48:51], v[32:47]
ds_read_b64_tr_b16 a[208:209], v24 offset:12288
ds_read_b64_tr_b16 a[210:211], v24 offset:13312
ds_read_b64_tr_b16 a[212:213], v25 offset:12288
v_lshlrev_b32 v220, 16, v174
v_and_b32 v221, 0xffff0000, v174
v_mfma_f32_32x32x16_bf16 v[48:63], a[196:199], a[48:51], v[48:63]
ds_read_b64_tr_b16 a[214:215], v25 offset:13312
ds_read_b64_tr_b16 a[216:217], v24 offset:14336
ds_read_b64_tr_b16 a[218:219], v24 offset:15360
v_lshlrev_b32 v222, 16, v175
s_add_u32 m0, s41, 73728
v_mfma_f32_32x32x16_bf16 v[32:47], a[200:203], a[52:55], v[32:47]
buffer_load_dwordx4 v8, s[16:19], s59 offen lds
ds_read_b64_tr_b16 a[220:221], v25 offset:14336
ds_read_b64_tr_b16 a[222:223], v25 offset:15360
s_add_u32 m0, s41, 77824
v_mfma_f32_32x32x16_bf16 v[48:63], a[204:207], a[52:55], v[48:63]
buffer_load_dwordx4 v10, s[16:19], s59 offen lds
s_waitcnt vmcnt(11) lgkmcnt(0)
v_mfma_f32_32x32x16_bf16 v[32:47], a[208:211], a[56:59], v[32:47]
ds_read_b64_tr_b16 a[192:193], v24 offset:20480
ds_read_b64_tr_b16 a[194:195], v24 offset:21504
ds_read_b64_tr_b16 a[196:197], v25 offset:20480
v_and_b32 v223, 0xffff0000, v175
v_mfma_f32_32x32x16_bf16 v[48:63], a[212:215], a[56:59], v[48:63]
ds_read_b64_tr_b16 a[198:199], v25 offset:21504
ds_read_b64_tr_b16 a[200:201], v24 offset:22528
ds_read_b64_tr_b16 a[202:203], v24 offset:23552
s_add_u32 m0, s41, 81920
v_mfma_f32_32x32x16_bf16 v[32:47], a[216:219], a[60:63], v[32:47]
buffer_load_dwordx4 v8, s[16:19], s60 offen lds
ds_read_b64_tr_b16 a[204:205], v25 offset:22528
ds_read_b64_tr_b16 a[206:207], v25 offset:23552
s_add_u32 m0, s41, 86016
v_mfma_f32_32x32x16_bf16 v[48:63], a[220:223], a[60:63], v[48:63]
buffer_load_dwordx4 v10, s[16:19], s60 offen lds
s_waitcnt vmcnt(11) lgkmcnt(0)
v_mfma_f32_32x32x16_bf16 v[32:47], a[192:195], a[64:67], v[32:47]
ds_read_b64_tr_b16 a[208:209], v24 offset:24576
ds_read_b64_tr_b16 a[210:211], v24 offset:25600
ds_read_b64_tr_b16 a[212:213], v25 offset:24576
v_mfma_f32_32x32x16_bf16 v[48:63], a[196:199], a[64:67], v[48:63]
ds_read_b64_tr_b16 a[214:215], v25 offset:25600
ds_read_b64_tr_b16 a[216:217], v24 offset:26624
ds_read_b64_tr_b16 a[218:219], v24 offset:27648
s_add_u32 m0, s41, 90112
v_mfma_f32_32x32x16_bf16 v[32:47], a[200:203], a[68:71], v[32:47]
buffer_load_dwordx4 v8, s[16:19], s61 offen lds
ds_read_b64_tr_b16 a[220:221], v25 offset:26624
ds_read_b64_tr_b16 a[222:223], v25 offset:27648
s_add_u32 m0, s41, 94208
v_mfma_f32_32x32x16_bf16 v[48:63], a[204:207], a[68:71], v[48:63]
buffer_load_dwordx4 v10, s[16:19], s61 offen lds
s_waitcnt vmcnt(10) lgkmcnt(0)
v_mfma_f32_32x32x16_bf16 v[32:47], a[208:211], a[72:75], v[32:47]
ds_read_b64_tr_b16 a[192:193], v20 offset:32768
ds_read_b64_tr_b16 a[194:195], v20 offset:33792
ds_read_b64_tr_b16 a[196:197], v21 offset:32768
v_mfma_f32_32x32x16_bf16 v[48:63], a[212:215], a[72:75], v[48:63]
ds_read_b64_tr_b16 a[198:199], v21 offset:33792
ds_read_b64_tr_b16 a[200:201], v20 offset:34816
ds_read_b64_tr_b16 a[202:203], v20 offset:35840
v_mfma_f32_32x32x16_bf16 v[32:47], a[216:219], a[76:79], v[32:47]
s_mov_b32 s45, 16384
buffer_load_dwordx2 v[0:1], v30, s[24:27], s45 offen sc1
ds_read_b64_tr_b16 a[204:205], v21 offset:34816
ds_read_b64_tr_b16 a[206:207], v21 offset:35840
s_add_u32 m0, s41, 98304
v_mfma_f32_32x32x16_bf16 v[48:63], a[220:223], a[76:79], v[48:63]
buffer_load_dwordx4 v8, s[16:19], s62 offen lds
s_waitcnt vmcnt(10) lgkmcnt(0)
v_mfma_f32_32x32x16_bf16 v[32:47], a[192:195], a[80:83], v[32:47]
ds_read_b64_tr_b16 a[208:209], v20 offset:36864
ds_read_b64_tr_b16 a[210:211], v20 offset:37888
ds_read_b64_tr_b16 a[212:213], v21 offset:36864
v_mfma_f32_32x32x16_bf16 v[48:63], a[196:199], a[80:83], v[48:63]
ds_read_b64_tr_b16 a[214:215], v21 offset:37888
ds_read_b64_tr_b16 a[216:217], v20 offset:38912
ds_read_b64_tr_b16 a[218:219], v20 offset:39936
s_add_u32 m0, s41, 102400
v_mfma_f32_32x32x16_bf16 v[32:47], a[200:203], a[84:87], v[32:47]
buffer_load_dwordx4 v10, s[16:19], s62 offen lds
ds_read_b64_tr_b16 a[220:221], v21 offset:38912
ds_read_b64_tr_b16 a[222:223], v21 offset:39936
s_add_u32 m0, s41, 106496
v_mfma_f32_32x32x16_bf16 v[48:63], a[204:207], a[84:87], v[48:63]
buffer_load_dwordx4 v9, s[16:19], s54 offen lds
s_waitcnt vmcnt(10) lgkmcnt(0)
v_mfma_f32_32x32x16_bf16 v[32:47], a[208:211], a[88:91], v[32:47]
s_barrier
ds_read_b64_tr_b16 a[192:193], v20 offset:40960
ds_read_b64_tr_b16 a[194:195], v20 offset:41984
v_mfma_f32_32x32x16_bf16 v[48:63], a[212:215], a[88:91], v[48:63]
ds_read_b64_tr_b16 a[196:197], v21 offset:40960
ds_read_b64_tr_b16 a[198:199], v21 offset:41984
ds_read_b64_tr_b16 a[200:201], v20 offset:43008
v_mfma_f32_32x32x16_bf16 v[32:47], a[216:219], a[92:95], v[32:47]
s_mov_b32 s44, 81920
s_cmp_lg_u32 s32, 0
s_cbranch_scc0 L_mr_fl5x
buffer_store_dwordx2 v[6:7], v31, s[24:27], s44 offen
L_mr_fl5j:
ds_read_b64_tr_b16 a[202:203], v20 offset:44032
ds_read_b64_tr_b16 a[204:205], v21 offset:43008
ds_read_b64_tr_b16 a[206:207], v21 offset:44032
s_add_u32 m0, s41, 0
v_mfma_f32_32x32x16_bf16 v[48:63], a[220:223], a[92:95], v[48:63]
buffer_load_dwordx4 v11, s[16:19], s54 offen lds
s_waitcnt lgkmcnt(0)
v_mfma_f32_32x32x16_bf16 v[64:79], a[192:195], a[0:3], v[64:79]
ds_read_b64_tr_b16 a[208:209], v20 offset:45056
ds_read_b64_tr_b16 a[210:211], v20 offset:46080
ds_read_b64_tr_b16 a[212:213], v21 offset:45056
s_waitcnt vmcnt(5)
L_mr_sp01:
v_cmp_eq_u64 vcc, s[48:49], v[0:1]
s_nop 1
s_and_b32 s44, vcc_lo, 63
s_cmp_eq_u32 s44, 63
s_cbranch_scc0 L_mr_ok01x
L_mr_ok01:
v_mfma_f32_32x32x16_bf16 v[80:95], a[196:199], a[0:3], v[80:95]
ds_read_b64_tr_b16 a[214:215], v21 offset:46080
ds_read_b64_tr_b16 a[216:217], v20 offset:47104
ds_read_b64_tr_b16 a[218:219], v20 offset:48128
v_mfma_f32_32x32x16_bf16 v[64:79], a[200:203], a[4:7], v[64:79]
buffer_load_dwordx4 a[96:99], v26, s[76:79], s71 offen offset:0 sc1
ds_read_b64_tr_b16 a[220:221], v21 offset:47104
ds_read_b64_tr_b16 a[222:223], v21 offset:48128
v_mfma_f32_32x32x16_bf16 v[80:95], a[204:207], a[4:7], v[80:95]
buffer_load_dwordx4 a[100:103], v26, s[76:79], s71 offen offset:1024 sc1
s_waitcnt lgkmcnt(0)
v_mfma_f32_32x32x16_bf16 v[64:79], a[208:211], a[8:11], v[64:79]
ds_read_b64_tr_b16 a[192:193], v20 offset:49152
ds_read_b64_tr_b16 a[194:195], v20 offset:50176
ds_read_b64_tr_b16 a[196:197], v21 offset:49152
v_mfma_f32_32x32x16_bf16 v[80:95], a[212:215], a[8:11], v[80:95]
ds_read_b64_tr_b16 a[198:199], v21 offset:50176
ds_read_b64_tr_b16 a[200:201], v20 offset:51200
ds_read_b64_tr_b16 a[202:203], v20 offset:52224
v_mfma_f32_32x32x16_bf16 v[64:79], a[216:219], a[12:15], v[64:79]
buffer_load_dwordx4 a[104:107], v26, s[76:79], s71 offen offset:2048 sc1
ds_read_b64_tr_b16 a[204:205], v21 offset:51200
ds_read_b64_tr_b16 a[206:207], v21 offset:52224
v_mfma_f32_32x32x16_bf16 v[80:95], a[220:223], a[12:15], v[80:95]
buffer_load_dwordx4 a[108:111], v26, s[76:79], s71 offen offset:3072 sc1
s_waitcnt lgkmcnt(0)
v_mfma_f32_32x32x16_bf16 v[64:79], a[192:195], a[16:19], v[64:79]
ds_read_b64_tr_b16 a[208:209], v20 offset:53248
ds_read_b64_tr_b16 a[210:211], v20 offset:54272
ds_read_b64_tr_b16 a[212:213], v21 offset:53248
v_mfma_f32_32x32x16_bf16 v[80:95], a[196:199], a[16:19], v[80:95]
ds_read_b64_tr_b16 a[214:215], v21 offset:54272
ds_read_b64_tr_b16 a[216:217], v20 offset:55296
ds_read_b64_tr_b16 a[218:219], v20 offset:56320
v_mfma_f32_32x32x16_bf16 v[64:79], a[200:203], a[20:23], v[64:79]
buffer_load_dwordx4 a[112:115], v26, s[76:79], s72 offen offset:0 sc1
ds_read_b64_tr_b16 a[220:221], v21 offset:55296
ds_read_b64_tr_b16 a[222:223], v21 offset:56320
v_mfma_f32_32x32x16_bf16 v[80:95], a[204:207], a[20:23], v[80:95]
buffer_load_dwordx4 a[116:119], v26, s[76:79], s72 offen offset:1024 sc1
s_waitcnt lgkmcnt(0)
v_mfma_f32_32x32x16_bf16 v[64:79], a[208:211], a[24:27], v[64:79]
ds_read_b64_tr_b16 a[192:193], v20 offset:57344
ds_read_b64_tr_b16 a[194:195], v20 offset:58368
ds_read_b64_tr_b16 a[196:197], v21 offset:57344
v_mfma_f32_32x32x16_bf16 v[80:95], a[212:215], a[24:27], v[80:95]
ds_read_b64_tr_b16 a[198:199], v21 offset:58368
ds_read_b64_tr_b16 a[200:201], v20 offset:59392
ds_read_b64_tr_b16 a[202:203], v20 offset:60416
v_mfma_f32_32x32x16_bf16 v[64:79], a[216:219], a[28:31], v[64:79]
buffer_load_dwordx4 a[120:123], v26, s[76:79], s72 offen offset:2048 sc1
ds_read_b64_tr_b16 a[204:205], v21 offset:59392
ds_read_b64_tr_b16 a[206:207], v21 offset:60416
v_mfma_f32_32x32x16_bf16 v[80:95], a[220:223], a[28:31], v[80:95]
buffer_load_dwordx4 a[124:127], v26, s[76:79], s72 offen offset:3072 sc1
s_waitcnt lgkmcnt(0)
v_mfma_f32_32x32x16_bf16 v[64:79], a[192:195], a[32:35], v[64:79]
ds_read_b64_tr_b16 a[208:209], v20 offset:61440
ds_read_b64_tr_b16 a[210:211], v20 offset:62464
ds_read_b64_tr_b16 a[212:213], v21 offset:61440
v_mfma_f32_32x32x16_bf16 v[80:95], a[196:199], a[32:35], v[80:95]
ds_read_b64_tr_b16 a[214:215], v21 offset:62464
ds_read_b64_tr_b16 a[216:217], v20 offset:63488
ds_read_b64_tr_b16 a[218:219], v20 offset:64512
v_mfma_f32_32x32x16_bf16 v[64:79], a[200:203], a[36:39], v[64:79]
buffer_load_dwordx4 a[128:131], v26, s[76:79], s73 offen offset:0 sc1
ds_read_b64_tr_b16 a[220:221], v21 offset:63488
ds_read_b64_tr_b16 a[222:223], v21 offset:64512
v_mfma_f32_32x32x16_bf16 v[80:95], a[204:207], a[36:39], v[80:95]
buffer_load_dwordx4 a[132:135], v26, s[76:79], s73 offen offset:1024 sc1
s_waitcnt lgkmcnt(0)
v_mfma_f32_32x32x16_bf16 v[64:79], a[208:211], a[40:43], v[64:79]
s_barrier
ds_read_b64_tr_b16 a[192:193], v22 offset:0
ds_read_b64_tr_b16 a[194:195], v22 offset:1024
v_mfma_f32_32x32x16_bf16 v[80:95], a[212:215], a[40:43], v[80:95]
ds_read_b64_tr_b16 a[196:197], v23 offset:0
ds_read_b64_tr_b16 a[198:199], v23 offset:1024
ds_read_b64_tr_b16 a[200:201], v22 offset:2048
v_mfma_f32_32x32x16_bf16 v[64:79], a[216:219], a[44:47], v[64:79]
buffer_load_dwordx4 a[136:139], v26, s[76:79], s73 offen offset:2048 sc1
ds_read_b64_tr_b16 a[202:203], v22 offset:3072
ds_read_b64_tr_b16 a[204:205], v23 offset:2048
ds_read_b64_tr_b16 a[206:207], v23 offset:3072
v_mfma_f32_32x32x16_bf16 v[80:95], a[220:223], a[44:47], v[80:95]
buffer_load_dwordx4 a[140:143], v26, s[76:79], s73 offen offset:3072 sc1
s_waitcnt vmcnt(10) lgkmcnt(0)
v_mfma_f32_32x32x16_bf16 v[32:47], a[192:195], a[96:99], v[32:47]
ds_read_b64_tr_b16 a[208:209], v22 offset:4096
ds_read_b64_tr_b16 a[210:211], v22 offset:5120
ds_read_b64_tr_b16 a[212:213], v23 offset:4096
s_add_u32 m0, s41, 4096
v_mfma_f32_32x32x16_bf16 v[48:63], a[196:199], a[96:99], v[48:63]
buffer_load_dwordx4 v9, s[16:19], s55 offen lds
ds_read_b64_tr_b16 a[214:215], v23 offset:5120
ds_read_b64_tr_b16 a[216:217], v22 offset:6144
ds_read_b64_tr_b16 a[218:219], v22 offset:7168
v_mfma_f32_32x32x16_bf16 v[32:47], a[200:203], a[100:103], v[32:47]
buffer_load_dwordx4 a[144:147], v26, s[76:79], s74 offen offset:0 sc1
ds_read_b64_tr_b16 a[220:221], v23 offset:6144
ds_read_b64_tr_b16 a[222:223], v23 offset:7168
v_mfma_f32_32x32x16_bf16 v[48:63], a[204:207], a[100:103], v[48:63]
buffer_load_dwordx4 a[148:151], v26, s[76:79], s74 offen offset:1024 sc1
s_waitcnt vmcnt(11) lgkmcnt(0)
v_mfma_f32_32x32x16_bf16 v[32:47], a[208:211], a[104:107], v[32:47]
ds_read_b64_tr_b16 a[192:193], v22 offset:8192
ds_read_b64_tr_b16 a[194:195], v22 offset:9216
ds_read_b64_tr_b16 a[196:197], v23 offset:8192
s_add_u32 m0, s41, 8192
v_mfma_f32_32x32x16_bf16 v[48:63], a[212:215], a[104:107], v[48:63]
buffer_load_dwordx4 v11, s[16:19], s55 offen lds
ds_read_b64_tr_b16 a[198:199], v23 offset:9216
ds_read_b64_tr_b16 a[200:201], v22 offset:10240
ds_read_b64_tr_b16 a[202:203], v22 offset:11264
v_mfma_f32_32x32x16_bf16 v[32:47], a[216:219], a[108:111], v[32:47]
buffer_load_dwordx4 a[152:155], v26, s[76:79], s74 offen offset:2048 sc1
ds_read_b64_tr_b16 a[204:205], v23 offset:10240
ds_read_b64_tr_b16 a[206:207], v23 offset:11264
v_mfma_f32_32x32x16_bf16 v[48:63], a[220:223], a[108:111], v[48:63]
buffer_load_dwordx4 a[156:159], v26, s[76:79], s74 offen offset:3072 sc1
s_waitcnt vmcnt(12) lgkmcnt(0)
v_mfma_f32_32x32x16_bf16 v[32:47], a[192:195], a[112:115], v[32:47]
ds_read_b64_tr_b16 a[208:209], v22 offset:12288
ds_read_b64_tr_b16 a[210:211], v22 offset:13312
ds_read_b64_tr_b16 a[212:213], v23 offset:12288
v_mfma_f32_32x32x16_bf16 v[48:63], a[196:199], a[112:115], v[48:63]
s_mov_b32 s45, 81920
buffer_load_dwordx2 v[0:1], v30, s[24:27], s45 offen sc1
ds_read_b64_tr_b16 a[214:215], v23 offset:13312
ds_read_b64_tr_b16 a[216:217], v22 offset:14336
ds_read_b64_tr_b16 a[218:219], v22 offset:15360
s_add_u32 m0, s41, 12288
v_mfma_f32_32x32x16_bf16 v[32:47], a[200:203], a[116:119], v[32:47]
buffer_load_dwordx4 v9, s[16:19], s56 offen lds
ds_read_b64_tr_b16 a[220:221], v23 offset:14336
ds_read_b64_tr_b16 a[222:223], v23 offset:15360
v_mfma_f32_32x32x16_bf16 v[48:63], a[204:207], a[116:119], v[48:63]
buffer_load_dwordx4 a[160:163], v26, s[76:79], s75 offen offset:0 sc1
s_waitcnt vmcnt(13) lgkmcnt(0)
v_mfma_f32_32x32x16_bf16 v[32:47], a[208:211], a[120:123], v[32:47]
ds_read_b64_tr_b16 a[192:193], v22 offset:16384
ds_read_b64_tr_b16 a[194:195], v22 offset:17408
ds_read_b64_tr_b16 a[196:197], v23 offset:16384
v_mfma_f32_32x32x16_bf16 v[48:63], a[212:215], a[120:123], v[48:63]
buffer_load_dwordx4 a[164:167], v26, s[76:79], s75 offen offset:1024 sc1
ds_read_b64_tr_b16 a[198:199], v23 offset:17408
ds_read_b64_tr_b16 a[200:201], v22 offset:18432
ds_read_b64_tr_b16 a[202:203], v22 offset:19456
s_add_u32 m0, s41, 16384
v_mfma_f32_32x32x16_bf16 v[32:47], a[216:219], a[124:127], v[32:47]
buffer_load_dwordx4 v11, s[16:19], s56 offen lds
ds_read_b64_tr_b16 a[204:205], v23 offset:18432
ds_read_b64_tr_b16 a[206:207], v23 offset:19456
v_mfma_f32_32x32x16_bf16 v[48:63], a[220:223], a[124:127], v[48:63]
buffer_load_dwordx4 a[168:171], v26, s[76:79], s75 offen offset:2048 sc1
s_waitcnt vmcnt(14) lgkmcnt(0)
v_mfma_f32_32x32x16_bf16 v[32:47], a[192:195], a[128:131], v[32:47]
ds_read_b64_tr_b16 a[208:209], v22 offset:20480
ds_read_b64_tr_b16 a[210:211], v22 offset:21504
ds_read_b64_tr_b16 a[212:213], v23 offset:20480
v_mfma_f32_32x32x16_bf16 v[48:63], a[196:199], a[128:131], v[48:63]
buffer_load_dwordx4 a[172:175], v26, s[76:79], s75 offen offset:3072 sc1
ds_read_b64_tr_b16 a[214:215], v23 offset:21504
ds_read_b64_tr_b16 a[216:217], v22 offset:22528
ds_read_b64_tr_b16 a[218:219], v22 offset:23552
s_add_u32 m0, s41, 20480
v_mfma_f32_32x32x16_bf16 v[32:47], a[200:203], a[132:135], v[32:47]
buffer_load_dwordx4 v9, s[16:19], s58 offen lds
ds_read_b64_tr_b16 a[220:221], v23 offset:22528
ds_read_b64_tr_b16 a[222:223], v23 offset:23552
s_add_u32 m0, s41, 24576
v_mfma_f32_32x32x16_bf16 v[48:63], a[204:207], a[132:135], v[48:63]
buffer_load_dwordx4 v11, s[16:19], s58 offen lds
s_waitcnt vmcnt(15) lgkmcnt(0)
v_mfma_f32_32x32x16_bf16 v[32:47], a[208:211], a[136:139], v[32:47]
s_barrier
ds_read_b64_tr_b16 a[192:193], v22 offset:24576
ds_read_b64_tr_b16 a[194:195], v22 offset:25600
v_mfma_f32_32x32x16_bf16 v[48:63], a[212:215], a[136:139], v[48:63]
ds_read_b64_tr_b16 a[196:197], v23 offset:24576
ds_read_b64_tr_b16 a[198:199], v23 offset:25600
ds_read_b64_tr_b16 a[200:201], v22 offset:26624
s_waitcnt vmcnt(8)
L_mr_sp88:
v_cmp_eq_u64 vcc, s[48:49], v[0:1]
s_nop 1
s_and_b32 s44, vcc_lo, 127
s_cmp_eq_u32 s44, 127
s_cbranch_scc0 L_mr_ok88x
L_mr_ok88:
s_add_u32 m0, s41, 28672
v_mfma_f32_32x32x16_bf16 v[32:47], a[216:219], a[140:143], v[32:47]
buffer_load_dwordx4 v9, s[16:19], s59 offen lds
ds_read_b64_tr_b16 a[202:203], v22 offset:27648
ds_read_b64_tr_b16 a[204:205], v23 offset:26624
ds_read_b64_tr_b16 a[206:207], v23 offset:27648
s_add_u32 m0, s41, 114688
v_mfma_f32_32x32x16_bf16 v[48:63], a[220:223], a[140:143], v[48:63]
buffer_load_dwordx4 v11, s[16:19], s59 offen lds
s_waitcnt lgkmcnt(0)
v_mfma_f32_32x32x16_bf16 v[32:47], a[192:195], a[144:147], v[32:47]
ds_read_b64_tr_b16 a[208:209], v22 offset:28672
ds_read_b64_tr_b16 a[210:211], v22 offset:29696
ds_read_b64_tr_b16 a[212:213], v23 offset:28672
v_mfma_f32_32x32x16_bf16 v[48:63], a[196:199], a[144:147], v[48:63]
ds_read_b64_tr_b16 a[214:215], v23 offset:29696
ds_read_b64_tr_b16 a[216:217], v22 offset:30720
ds_read_b64_tr_b16 a[218:219], v22 offset:31744
s_add_u32 m0, s41, 118784
v_mfma_f32_32x32x16_bf16 v[32:47], a[200:203], a[148:151], v[32:47]
buffer_load_dwordx4 v9, s[16:19], s60 offen lds
ds_read_b64_tr_b16 a[220:221], v23 offset:30720
ds_read_b64_tr_b16 a[222:223], v23 offset:31744
s_add_u32 m0, s41, 126976
v_mfma_f32_32x32x16_bf16 v[48:63], a[204:207], a[148:151], v[48:63]
buffer_load_dwordx4 v11, s[16:19], s60 offen lds
s_waitcnt lgkmcnt(0)
v_mfma_f32_32x32x16_bf16 v[32:47], a[208:211], a[152:155], v[32:47]
ds_read_b64_tr_b16 a[192:193], v22 offset:32768
ds_read_b64_tr_b16 a[194:195], v22 offset:33792
ds_read_b64_tr_b16 a[196:197], v23 offset:32768
v_mfma_f32_32x32x16_bf16 v[48:63], a[212:215], a[152:155], v[48:63]
ds_read_b64_tr_b16 a[198:199], v23 offset:33792
ds_read_b64_tr_b16 a[200:201], v22 offset:34816
ds_read_b64_tr_b16 a[202:203], v22 offset:35840
s_add_u32 m0, s41, 131072
v_mfma_f32_32x32x16_bf16 v[32:47], a[216:219], a[156:159], v[32:47]
buffer_load_dwordx4 v9, s[16:19], s61 offen lds
ds_read_b64_tr_b16 a[204:205], v23 offset:34816
ds_read_b64_tr_b16 a[206:207], v23 offset:35840
s_add_u32 m0, s41, 139264
v_mfma_f32_32x32x16_bf16 v[48:63], a[220:223], a[156:159], v[48:63]
buffer_load_dwordx4 v11, s[16:19], s61 offen lds
s_waitcnt vmcnt(11) lgkmcnt(0)
v_mfma_f32_32x32x16_bf16 v[32:47], a[192:195], a[160:163], v[32:47]
ds_read_b64_tr_b16 a[208:209], v22 offset:36864
ds_read_b64_tr_b16 a[210:211], v22 offset:37888
ds_read_b64_tr_b16 a[212:213], v23 offset:36864
v_mfma_f32_32x32x16_bf16 v[48:63], a[196:199], a[160:163], v[48:63]
ds_read_b64_tr_b16 a[214:215], v23 offset:37888
ds_read_b64_tr_b16 a[216:217], v22 offset:38912
ds_read_b64_tr_b16 a[218:219], v22 offset:39936
s_add_u32 m0, s41, 143360
v_mfma_f32_32x32x16_bf16 v[32:47], a[200:203], a[164:167], v[32:47]
buffer_load_dwordx4 v9, s[16:19], s62 offen lds
ds_read_b64_tr_b16 a[220:221], v23 offset:38912
ds_read_b64_tr_b16 a[222:223], v23 offset:39936
s_add_u32 m0, s41, 151552
v_mfma_f32_32x32x16_bf16 v[48:63], a[204:207], a[164:167], v[48:63]
buffer_load_dwordx4 v11, s[16:19], s62 offen lds
s_waitcnt vmcnt(10) lgkmcnt(0)
v_mfma_f32_32x32x16_bf16 v[32:47], a[208:211], a[168:171], v[32:47]
ds_read_b64_tr_b16 a[192:193], v22 offset:40960
ds_read_b64_tr_b16 a[194:195], v22 offset:41984
ds_read_b64_tr_b16 a[196:197], v23 offset:40960
v_mfma_f32_32x32x16_bf16 v[48:63], a[212:215], a[168:171], v[48:63]
ds_read_b64_tr_b16 a[198:199], v23 offset:41984
ds_read_b64_tr_b16 a[200:201], v22 offset:43008
ds_read_b64_tr_b16 a[202:203], v22 offset:44032
s_add_u32 s16, s16, 1384448
s_addc_u32 s17, s17, 0
s_sub_u32 s18, s18, 1384448
s_add_u32 m0, s41, 155648
v_mfma_f32_32x32x16_bf16 v[32:47], a[216:219], a[172:175], v[32:47]
buffer_load_dwordx4 v8, s[16:19], s50 offen lds
ds_read_b64_tr_b16 a[204:205], v23 offset:43008
ds_read_b64_tr_b16 a[206:207], v23 offset:44032
s_add_u32 m0, s41, 32768
v_mfma_f32_32x32x16_bf16 v[48:63], a[220:223], a[172:175], v[48:63]
buffer_load_dwordx4 v10, s[16:19], s50 offen lds
s_waitcnt lgkmcnt(0)
v_mfma_f32_32x32x16_bf16 v[64:79], a[192:195], a[48:51], v[64:79]
ds_read_b64_tr_b16 a[208:209], v20 offset:0
ds_read_b64_tr_b16 a[210:211], v20 offset:1024
ds_read_b64_tr_b16 a[212:213], v21 offset:0
v_mfma_f32_32x32x16_bf16 v[80:95], a[196:199], a[48:51], v[80:95]
ds_read_b64_tr_b16 a[214:215], v21 offset:1024
ds_read_b64_tr_b16 a[216:217], v20 offset:2048
ds_read_b64_tr_b16 a[218:219], v20 offset:3072
v_fma_f32 v32, v96, v32, v192
v_fma_f32 v33, v97, v33, v193
v_cvt_pk_bf16_f32 v160, v32, v33
v_mfma_f32_32x32x16_bf16 v[64:79], a[200:203], a[52:55], v[64:79]
ds_read_b64_tr_b16 a[220:221], v21 offset:2048
ds_read_b64_tr_b16 a[222:223], v21 offset:3072
v_fma_f32 v34, v98, v34, v194
v_fma_f32 v35, v99, v35, v195
v_cvt_pk_bf16_f32 v161, v34, v35
v_fma_f32 v36, v100, v36, v196
v_mfma_f32_32x32x16_bf16 v[80:95], a[204:207], a[52:55], v[80:95]
v_fma_f32 v37, v101, v37, v197
v_cvt_pk_bf16_f32 v162, v36, v37
v_fma_f32 v38, v102, v38, v198
v_fma_f32 v39, v103, v39, v199
v_cvt_pk_bf16_f32 v163, v38, v39
s_waitcnt vmcnt(10) lgkmcnt(0)
v_mfma_f32_32x32x16_bf16 v[64:79], a[208:211], a[56:59], v[64:79]
s_barrier
ds_read_b64_tr_b16 a[192:193], v20 offset:4096
ds_read_b64_tr_b16 a[194:195], v20 offset:5120
v_fma_f32 v40, v104, v40, v200
v_mfma_f32_32x32x16_bf16 v[80:95], a[212:215], a[56:59], v[80:95]
ds_read_b64_tr_b16 a[196:197], v21 offset:4096
ds_read_b64_tr_b16 a[198:199], v21 offset:5120
ds_read_b64_tr_b16 a[200:201], v20 offset:6144
v_fma_f32 v41, v105, v41, v201
v_cvt_pk_bf16_f32 v164, v40, v41
v_fma_f32 v42, v106, v42, v202
v_mfma_f32_32x32x16_bf16 v[64:79], a[216:219], a[60:63], v[64:79]
s_add_u32 s43, s63, 16777216
s_add_u32 s43, s43, s93
s_cmp_lg_u32 s32, 0
s_cbranch_scc0 L_mr_st100x
buffer_store_dwordx4 v[160:163], v26, s[24:27], s43 offen offset:0
L_mr_st100j:
ds_read_b64_tr_b16 a[202:203], v20 offset:7168
ds_read_b64_tr_b16 a[204:205], v21 offset:6144
ds_read_b64_tr_b16 a[206:207], v21 offset:7168
v_mfma_f32_32x32x16_bf16 v[80:95], a[220:223], a[60:63], v[80:95]
v_fma_f32 v43, v107, v43, v203
v_cvt_pk_bf16_f32 v165, v42, v43
v_fma_f32 v44, v108, v44, v204
v_fma_f32 v45, v109, v45, v205
v_cvt_pk_bf16_f32 v166, v44, v45
s_waitcnt lgkmcnt(0)
v_mfma_f32_32x32x16_bf16 v[64:79], a[192:195], a[64:67], v[64:79]
ds_read_b64_tr_b16 a[208:209], v20 offset:8192
ds_read_b64_tr_b16 a[210:211], v20 offset:9216
ds_read_b64_tr_b16 a[212:213], v21 offset:8192
v_fma_f32 v46, v110, v46, v206
v_fma_f32 v47, v111, v47, v207
v_cvt_pk_bf16_f32 v167, v46, v47
v_mfma_f32_32x32x16_bf16 v[80:95], a[196:199], a[64:67], v[80:95]
ds_read_b64_tr_b16 a[214:215], v21 offset:9216
ds_read_b64_tr_b16 a[216:217], v20 offset:10240
ds_read_b64_tr_b16 a[218:219], v20 offset:11264
v_fma_f32 v48, v112, v48, v208
v_fma_f32 v49, v113, v49, v209
v_cvt_pk_bf16_f32 v168, v48, v49
v_mfma_f32_32x32x16_bf16 v[64:79], a[200:203], a[68:71], v[64:79]
s_cmp_lg_u32 s32, 0
s_cbranch_scc0 L_mr_st101x
buffer_store_dwordx4 v[164:167], v26, s[24:27], s43 offen offset:1024
L_mr_st101j:
ds_read_b64_tr_b16 a[220:221], v21 offset:10240
ds_read_b64_tr_b16 a[222:223], v21 offset:11264
v_mfma_f32_32x32x16_bf16 v[80:95], a[204:207], a[68:71], v[80:95]
v_fma_f32 v50, v114, v50, v210
v_fma_f32 v51, v115, v51, v211
v_cvt_pk_bf16_f32 v169, v50, v51
v_fma_f32 v52, v116, v52, v212
v_fma_f32 v53, v117, v53, v213
s_waitcnt lgkmcnt(0)
v_mfma_f32_32x32x16_bf16 v[64:79], a[208:211], a[72:75], v[64:79]
ds_read_b64_tr_b16 a[192:193], v20 offset:12288
ds_read_b64_tr_b16 a[194:195], v20 offset:13312
ds_read_b64_tr_b16 a[196:197], v21 offset:12288
v_cvt_pk_bf16_f32 v170, v52, v53
v_fma_f32 v54, v118, v54, v214
v_fma_f32 v55, v119, v55, v215
v_mfma_f32_32x32x16_bf16 v[80:95], a[212:215], a[72:75], v[80:95]
ds_read_b64_tr_b16 a[198:199], v21 offset:13312
ds_read_b64_tr_b16 a[200:201], v20 offset:14336
ds_read_b64_tr_b16 a[202:203], v20 offset:15360
v_cvt_pk_bf16_f32 v171, v54, v55
v_fma_f32 v56, v120, v56, v216
v_fma_f32 v57, v121, v57, v217
v_mfma_f32_32x32x16_bf16 v[64:79], a[216:219], a[76:79], v[64:79]
ds_read_b64_tr_b16 a[204:205], v21 offset:14336
ds_read_b64_tr_b16 a[206:207], v21 offset:15360
v_cvt_pk_bf16_f32 v172, v56, v57
v_fma_f32 v58, v122, v58, v218
v_fma_f32 v59, v123, v59, v219
v_cvt_pk_bf16_f32 v173, v58, v59
v_mfma_f32_32x32x16_bf16 v[80:95], a[220:223], a[76:79], v[80:95]
s_cmp_lg_u32 s32, 0
s_cbranch_scc0 L_mr_st102x
buffer_store_dwordx4 v[168:171], v26, s[24:27], s43 offen offset:2048
L_mr_st102j:
s_waitcnt lgkmcnt(0)
v_mfma_f32_32x32x16_bf16 v[64:79], a[192:195], a[80:83], v[64:79]
ds_read_b64_tr_b16 a[208:209], v20 offset:16384
ds_read_b64_tr_b16 a[210:211], v20 offset:17408
ds_read_b64_tr_b16 a[212:213], v21 offset:16384
v_fma_f32 v60, v124, v60, v220
v_fma_f32 v61, v125, v61, v221
v_cvt_pk_bf16_f32 v174, v60, v61
v_mfma_f32_32x32x16_bf16 v[80:95], a[196:199], a[80:83], v[80:95]
ds_read_b64_tr_b16 a[214:215], v21 offset:17408
ds_read_b64_tr_b16 a[216:217], v20 offset:18432
ds_read_b64_tr_b16 a[218:219], v20 offset:19456
v_fma_f32 v62, v126, v62, v222
v_fma_f32 v63, v127, v63, v223
v_cvt_pk_bf16_f32 v175, v62, v63
v_mfma_f32_32x32x16_bf16 v[64:79], a[200:203], a[84:87], v[64:79]
ds_read_b64_tr_b16 a[220:221], v21 offset:18432
ds_read_b64_tr_b16 a[222:223], v21 offset:19456
v_lshlrev_b32 v192, 16, v176
v_and_b32 v193, 0xffff0000, v176
v_lshlrev_b32 v194, 16, v177
v_mfma_f32_32x32x16_bf16 v[80:95], a[204:207], a[84:87], v[80:95]
s_cmp_lg_u32 s32, 0
s_cbranch_scc0 L_mr_st103x
buffer_store_dwordx4 v[172:175], v26, s[24:27], s43 offen offset:3072
L_mr_st103j:
v_and_b32 v195, 0xffff0000, v177
s_waitcnt lgkmcnt(0)
v_mfma_f32_32x32x16_bf16 v[64:79], a[208:211], a[88:91], v[64:79]
ds_read_b64_tr_b16 a[192:193], v20 offset:20480
ds_read_b64_tr_b16 a[194:195], v20 offset:21504
ds_read_b64_tr_b16 a[196:197], v21 offset:20480
v_lshlrev_b32 v196, 16, v178
v_and_b32 v197, 0xffff0000, v178
v_mfma_f32_32x32x16_bf16 v[80:95], a[212:215], a[88:91], v[80:95]
ds_read_b64_tr_b16 a[198:199], v21 offset:21504
ds_read_b64_tr_b16 a[200:201], v20 offset:22528
ds_read_b64_tr_b16 a[202:203], v20 offset:23552
v_lshlrev_b32 v198, 16, v179
s_add_u32 m0, s41, 36864
v_mfma_f32_32x32x16_bf16 v[64:79], a[216:219], a[92:95], v[64:79]
buffer_load_dwordx4 v8, s[16:19], s51 offen lds
ds_read_b64_tr_b16 a[204:205], v21 offset:22528
ds_read_b64_tr_b16 a[206:207], v21 offset:23552
v_and_b32 v199, 0xffff0000, v179
s_add_u32 m0, s41, 40960
v_mfma_f32_32x32x16_bf16 v[80:95], a[220:223], a[92:95], v[80:95]
buffer_load_dwordx4 v10, s[16:19], s51 offen lds
s_waitcnt lgkmcnt(0)
v_mfma_f32_32x32x16_bf16 v[64:79], a[192:195], a[96:99], v[64:79]
ds_read_b64_tr_b16 a[208:209], v20 offset:24576
ds_read_b64_tr_b16 a[210:211], v20 offset:25600
ds_read_b64_tr_b16 a[212:213], v21 offset:24576
v_lshlrev_b32 v200, 16, v180
v_and_b32 v201, 0xffff0000, v180
v_mfma_f32_32x32x16_bf16 v[80:95], a[196:199], a[96:99], v[80:95]
ds_read_b64_tr_b16 a[214:215], v21 offset:25600
ds_read_b64_tr_b16 a[216:217], v20 offset:26624
ds_read_b64_tr_b16 a[218:219], v20 offset:27648
v_lshlrev_b32 v202, 16, v181
s_add_u32 m0, s41, 45056
v_mfma_f32_32x32x16_bf16 v[64:79], a[200:203], a[100:103], v[64:79]
buffer_load_dwordx4 v8, s[16:19], s52 offen lds
ds_read_b64_tr_b16 a[220:221], v21 offset:26624
ds_read_b64_tr_b16 a[222:223], v21 offset:27648
s_add_u32 m0, s41, 49152
v_mfma_f32_32x32x16_bf16 v[80:95], a[204:207], a[100:103], v[80:95]
buffer_load_dwordx4 v10, s[16:19], s52 offen lds
v_and_b32 v203, 0xffff0000, v181
s_waitcnt vmcnt(12) lgkmcnt(0)
v_mfma_f32_32x32x16_bf16 v[64:79], a[208:211], a[104:107], v[64:79]
s_barrier
ds_read_b64_tr_b16 a[192:193], v20 offset:28672
ds_read_b64_tr_b16 a[194:195], v20 offset:29696
v_lshlrev_b32 v204, 16, v182
v_mfma_f32_32x32x16_bf16 v[80:95], a[212:215], a[104:107], v[80:95]
ds_read_b64_tr_b16 a[196:197], v21 offset:28672
ds_read_b64_tr_b16 a[198:199], v21 offset:29696
ds_read_b64_tr_b16 a[200:201], v20 offset:30720
v_and_b32 v205, 0xffff0000, v182
s_add_u32 m0, s41, 53248
v_mfma_f32_32x32x16_bf16 v[64:79], a[216:219], a[108:111], v[64:79]
buffer_load_dwordx4 v8, s[16:19], s57 offen lds
ds_read_b64_tr_b16 a[202:203], v20 offset:31744
ds_read_b64_tr_b16 a[204:205], v21 offset:30720
ds_read_b64_tr_b16 a[206:207], v21 offset:31744
v_lshlrev_b32 v206, 16, v183
s_add_u32 m0, s41, 57344
v_mfma_f32_32x32x16_bf16 v[80:95], a[220:223], a[108:111], v[80:95]
buffer_load_dwordx4 v10, s[16:19], s57 offen lds
s_waitcnt lgkmcnt(0)
v_mfma_f32_32x32x16_bf16 v[64:79], a[192:195], a[112:115], v[64:79]
ds_read_b64_tr_b16 a[208:209], v22 offset:49152
ds_read_b64_tr_b16 a[210:211], v22 offset:50176
ds_read_b64_tr_b16 a[212:213], v23 offset:49152
v_and_b32 v207, 0xffff0000, v183
ds_read_b128 v[224:227], v29 offset:1024
ds_read_b128 v[228:231], v29 offset:1056
v_mfma_f32_32x32x16_bf16 v[80:95], a[196:199], a[112:115], v[80:95]
ds_read_b64_tr_b16 a[214:215], v23 offset:50176
ds_read_b64_tr_b16 a[216:217], v22 offset:51200
ds_read_b64_tr_b16 a[218:219], v22 offset:52224
v_lshlrev_b32 v208, 16, v184
ds_read_b128 v[232:235], v29 offset:1088
ds_read_b128 v[236:239], v29 offset:1120
v_mfma_f32_32x32x16_bf16 v[64:79], a[200:203], a[116:119], v[64:79]
s_waitcnt vmcnt(6)
s_mov_b32 s44, 32768
s_cmp_lg_u32 s32, 0
s_cbranch_scc0 L_mr_fl2x
buffer_store_dwordx2 v[6:7], v31, s[24:27], s44 offen
L_mr_fl2j:
ds_read_b64_tr_b16 a[220:221], v23 offset:51200
ds_read_b64_tr_b16 a[222:223], v23 offset:52224
s_add_u32 m0, s41, 61440
v_mfma_f32_32x32x16_bf16 v[80:95], a[204:207], a[116:119], v[80:95]
buffer_load_dwordx4 v9, s[16:19], s50 offen lds
v_and_b32 v209, 0xffff0000, v184
s_waitcnt lgkmcnt(0)
v_mfma_f32_32x32x16_bf16 v[64:79], a[208:211], a[120:123], v[64:79]
ds_read_b64_tr_b16 a[192:193], v22 offset:53248
ds_read_b64_tr_b16 a[194:195], v22 offset:54272
ds_read_b64_tr_b16 a[196:197], v23 offset:53248
ds_read_b128 v[240:243], v29 offset:1152
ds_read_b128 v[244:247], v29 offset:1184
v_mfma_f32_32x32x16_bf16 v[80:95], a[212:215], a[120:123], v[80:95]
ds_read_b64_tr_b16 a[198:199], v23 offset:54272
ds_read_b64_tr_b16 a[200:201], v22 offset:55296
ds_read_b64_tr_b16 a[202:203], v22 offset:56320
v_lshlrev_b32 v210, 16, v185
ds_read_b128 v[248:251], v29 offset:1216
s_add_u32 m0, s41, 65536
v_mfma_f32_32x32x16_bf16 v[64:79], a[216:219], a[124:127], v[64:79]
buffer_load_dwordx4 v11, s[16:19], s50 offen lds
ds_read_b64_tr_b16 a[204:205], v23 offset:55296
ds_read_b64_tr_b16 a[206:207], v23 offset:56320
v_and_b32 v211, 0xffff0000, v185
s_add_u32 m0, s41, 69632
v_mfma_f32_32x32x16_bf16 v[80:95], a[220:223], a[124:127], v[80:95]
buffer_load_dwordx4 v9, s[16:19], s57 offen lds
ds_read_b128 v[252:255], v29 offset:1248
s_waitcnt lgkmcnt(1)
v_mfma_f32_32x32x16_bf16 v[64:79], a[192:195], a[128:131], v[64:79]
ds_read_b64_tr_b16 a[208:209], v22 offset:61440
ds_read_b64_tr_b16 a[210:211], v22 offset:62464
ds_read_b64_tr_b16 a[212:213], v23 offset:61440
v_lshlrev_b32 v212, 16, v186
v_and_b32 v213, 0xffff0000, v186
v_mfma_f32_32x32x16_bf16 v[80:95], a[196:199], a[128:131], v[80:95]
ds_read_b64_tr_b16 a[214:215], v23 offset:62464
ds_read_b64_tr_b16 a[216:217], v22 offset:63488
ds_read_b64_tr_b16 a[218:219], v22 offset:64512
v_lshlrev_b32 v214, 16, v187
s_add_u32 m0, s41, 73728
v_mfma_f32_32x32x16_bf16 v[64:79], a[200:203], a[132:135], v[64:79]
buffer_load_dwordx4 v11, s[16:19], s57 offen lds
ds_read_b64_tr_b16 a[220:221], v23 offset:63488
ds_read_b64_tr_b16 a[222:223], v23 offset:64512
v_and_b32 v215, 0xffff0000, v187
s_add_u32 m0, s41, 77824
v_mfma_f32_32x32x16_bf16 v[80:95], a[204:207], a[132:135], v[80:95]
buffer_load_dwordx4 v8, s[16:19], s53 offen lds
s_waitcnt lgkmcnt(0)
v_mfma_f32_32x32x16_bf16 v[64:79], a[208:211], a[136:139], v[64:79]
ds_read_b64_tr_b16 a[192:193], v24 offset:0
ds_read_b64_tr_b16 a[194:195], v24 offset:1024
ds_read_b64_tr_b16 a[196:197], v25 offset:0
v_lshlrev_b32 v216, 16, v188
v_and_b32 v217, 0xffff0000, v188
v_mfma_f32_32x32x16_bf16 v[80:95], a[212:215], a[136:139], v[80:95]
ds_read_b64_tr_b16 a[198:199], v25 offset:1024
ds_read_b64_tr_b16 a[200:201], v24 offset:2048
ds_read_b64_tr_b16 a[202:203], v24 offset:3072
v_lshlrev_b32 v218, 16, v189
s_add_u32 m0, s41, 81920
v_mfma_f32_32x32x16_bf16 v[64:79], a[216:219], a[140:143], v[64:79]
buffer_load_dwordx4 v10, s[16:19], s53 offen lds
ds_read_b64_tr_b16 a[204:205], v25 offset:2048
ds_read_b64_tr_b16 a[206:207], v25 offset:3072
s_add_u32 m0, s41, 86016
v_mfma_f32_32x32x16_bf16 v[80:95], a[220:223], a[140:143], v[80:95]
buffer_load_dwordx4 v8, s[16:19], s54 offen lds
v_and_b32 v219, 0xffff0000, v189
s_waitcnt lgkmcnt(0)
v_mfma_f32_32x32x16_bf16 v[64:79], a[192:195], a[144:147], v[64:79]
ds_read_b64_tr_b16 a[208:209], v24 offset:8192
ds_read_b64_tr_b16 a[210:211], v24 offset:9216
ds_read_b64_tr_b16 a[212:213], v25 offset:8192
v_lshlrev_b32 v220, 16, v190
v_and_b32 v221, 0xffff0000, v190
v_mfma_f32_32x32x16_bf16 v[80:95], a[196:199], a[144:147], v[80:95]
ds_read_b64_tr_b16 a[214:215], v25 offset:9216
ds_read_b64_tr_b16 a[216:217], v24 offset:10240
ds_read_b64_tr_b16 a[218:219], v24 offset:11264
v_lshlrev_b32 v222, 16, v191
v_and_b32 v223, 0xffff0000, v191
v_mfma_f32_32x32x16_bf16 v[64:79], a[200:203], a[148:151], v[64:79]
s_mov_b32 s45, 32768
buffer_load_dwordx2 v[0:1], v30, s[24:27], s45 offen sc1
ds_read_b64_tr_b16 a[220:221], v25 offset:10240
ds_read_b64_tr_b16 a[222:223], v25 offset:11264
s_add_u32 m0, s41, 90112
v_mfma_f32_32x32x16_bf16 v[80:95], a[204:207], a[148:151], v[80:95]
buffer_load_dwordx4 v10, s[16:19], s54 offen lds
s_waitcnt vmcnt(14) lgkmcnt(0)
v_mfma_f32_32x32x16_bf16 v[64:79], a[208:211], a[152:155], v[64:79]
s_barrier
ds_read_b64_tr_b16 a[192:193], v24 offset:12288
ds_read_b64_tr_b16 a[194:195], v24 offset:13312
v_mfma_f32_32x32x16_bf16 v[80:95], a[212:215], a[152:155], v[80:95]
ds_read_b64_tr_b16 a[196:197], v25 offset:12288
ds_read_b64_tr_b16 a[198:199], v25 offset:13312
ds_read_b64_tr_b16 a[200:201], v24 offset:14336
s_add_u32 m0, s41, 94208
v_mfma_f32_32x32x16_bf16 v[64:79], a[216:219], a[156:159], v[64:79]
buffer_load_dwordx4 v8, s[16:19], s55 offen lds
ds_read_b64_tr_b16 a[202:203], v24 offset:15360
ds_read_b64_tr_b16 a[204:205], v25 offset:14336
ds_read_b64_tr_b16 a[206:207], v25 offset:15360
s_add_u32 m0, s41, 98304
v_mfma_f32_32x32x16_bf16 v[80:95], a[220:223], a[156:159], v[80:95]
buffer_load_dwordx4 v10, s[16:19], s55 offen lds
s_waitcnt lgkmcnt(0)
v_mfma_f32_32x32x16_bf16 v[64:79], a[192:195], a[160:163], v[64:79]
ds_read_b64_tr_b16 a[208:209], v24 offset:20480
ds_read_b64_tr_b16 a[210:211], v24 offset:21504
ds_read_b64_tr_b16 a[212:213], v25 offset:20480
v_mfma_f32_32x32x16_bf16 v[80:95], a[196:199], a[160:163], v[80:95]
ds_read_b64_tr_b16 a[214:215], v25 offset:21504
ds_read_b64_tr_b16 a[216:217], v24 offset:22528
ds_read_b64_tr_b16 a[218:219], v24 offset:23552
s_add_u32 m0, s41, 102400
v_mfma_f32_32x32x16_bf16 v[64:79], a[200:203], a[164:167], v[64:79]
buffer_load_dwordx4 v8, s[16:19], s56 offen lds
ds_read_b64_tr_b16 a[220:221], v25 offset:22528
ds_read_b64_tr_b16 a[222:223], v25 offset:23552
s_add_u32 m0, s41, 106496
v_mfma_f32_32x32x16_bf16 v[80:95], a[204:207], a[164:167], v[80:95]
buffer_load_dwordx4 v10, s[16:19], s56 offen lds
s_waitcnt lgkmcnt(0)
v_mfma_f32_32x32x16_bf16 v[64:79], a[208:211], a[168:171], v[64:79]
ds_read_b64_tr_b16 a[192:193], v24 offset:24576
ds_read_b64_tr_b16 a[194:195], v24 offset:25600
ds_read_b64_tr_b16 a[196:197], v25 offset:24576
s_waitcnt vmcnt(5)
L_mr_sp10:
v_cmp_eq_u64 vcc, s[48:49], v[0:1]
s_nop 1
s_and_b32 s44, vcc_lo, 127
s_cmp_eq_u32 s44, 127
s_cbranch_scc0 L_mr_ok10x
L_mr_ok10:
v_mfma_f32_32x32x16_bf16 v[80:95], a[212:215], a[168:171], v[80:95]
ds_read_b64_tr_b16 a[198:199], v25 offset:25600
ds_read_b64_tr_b16 a[200:201], v24 offset:26624
ds_read_b64_tr_b16 a[202:203], v24 offset:27648
v_mfma_f32_32x32x16_bf16 v[64:79], a[216:219], a[172:175], v[64:79]
s_add_u32 s76, s76, s93
s_addc_u32 s77, s77, 0
buffer_load_dwordx4 a[0:3], v26, s[76:79], s64 offen offset:0 sc1
ds_read_b64_tr_b16 a[204:205], v25 offset:26624
ds_read_b64_tr_b16 a[206:207], v25 offset:27648
v_mfma_f32_32x32x16_bf16 v[80:95], a[220:223], a[172:175], v[80:95]
buffer_load_dwordx4 a[4:7], v26, s[76:79], s64 offen offset:1024 sc1
s_waitcnt lgkmcnt(0)
v_mfma_f32_32x32x16_bf16 v[32:47], a[192:195], v[160:163], v[224:239]
ds_read_b64_tr_b16 a[208:209], v20 offset:32768
ds_read_b64_tr_b16 a[210:211], v20 offset:33792
ds_read_b64_tr_b16 a[212:213], v21 offset:32768
v_mfma_f32_32x32x16_bf16 v[48:63], a[196:199], v[160:163], v[240:255]
buffer_load_dwordx4 a[8:11], v26, s[76:79], s64 offen offset:2048 sc1
ds_read_b64_tr_b16 a[214:215], v21 offset:33792
ds_read_b64_tr_b16 a[216:217], v20 offset:34816
ds_read_b64_tr_b16 a[218:219], v20 offset:35840
v_mfma_f32_32x32x16_bf16 v[32:47], a[200:203], v[164:167], v[32:47]
buffer_load_dwordx4 a[12:15], v26, s[76:79], s64 offen offset:3072 sc1
ds_read_b64_tr_b16 a[220:221], v21 offset:34816
ds_read_b64_tr_b16 a[222:223], v21 offset:35840
v_mfma_f32_32x32x16_bf16 v[48:63], a[204:207], v[164:167], v[48:63]
buffer_load_dwordx4 a[16:19], v26, s[76:79], s65 offen offset:0 sc1
ds_read_b128 v[224:227], v29 offset:1280
s_waitcnt lgkmcnt(1)
v_mfma_f32_32x32x16_bf16 v[32:47], a[208:211], v[168:171], v[32:47]
ds_read_b64_tr_b16 a[192:193], v20 offset:36864
ds_read_b64_tr_b16 a[194:195], v20 offset:37888
ds_read_b64_tr_b16 a[196:197], v21 offset:36864
ds_read_b128 v[228:231], v29 offset:1312
ds_read_b128 v[232:235], v29 offset:1344
v_fma_f32 v64, v128, v64, v192
v_mfma_f32_32x32x16_bf16 v[48:63], a[212:215], v[168:171], v[48:63]
buffer_load_dwordx4 a[20:23], v26, s[76:79], s65 offen offset:1024 sc1
ds_read_b64_tr_b16 a[198:199], v21 offset:37888
ds_read_b64_tr_b16 a[200:201], v20 offset:38912
ds_read_b64_tr_b16 a[202:203], v20 offset:39936
v_mfma_f32_32x32x16_bf16 v[32:47], a[216:219], v[172:175], v[32:47]
buffer_load_dwordx4 a[24:27], v26, s[76:79], s65 offen offset:2048 sc1
ds_read_b64_tr_b16 a[204:205], v21 offset:38912
ds_read_b64_tr_b16 a[206:207], v21 offset:39936
v_mfma_f32_32x32x16_bf16 v[48:63], a[220:223], v[172:175], v[48:63]
buffer_load_dwordx4 a[28:31], v26, s[76:79], s65 offen offset:3072 sc1
ds_read_b128 v[236:239], v29 offset:1376
s_waitcnt vmcnt(6) lgkmcnt(1)
v_mfma_f32_32x32x16_bf16 v[32:47], a[192:195], a[0:3], v[32:47]
ds_read_b64_tr_b16 a[208:209], v20 offset:40960
ds_read_b64_tr_b16 a[210:211], v20 offset:41984
ds_read_b64_tr_b16 a[212:213], v21 offset:40960
ds_read_b128 v[240:243], v29 offset:1408
ds_read_b128 v[244:247], v29 offset:1440
v_fma_f32 v65, v129, v65, v193
v_mfma_f32_32x32x16_bf16 v[48:63], a[196:199], a[0:3], v[48:63]
ds_read_b64_tr_b16 a[214:215], v21 offset:41984
ds_read_b64_tr_b16 a[216:217], v20 offset:43008
ds_read_b64_tr_b16 a[218:219], v20 offset:44032
ds_read_b128 v[248:251], v29 offset:1472
ds_read_b128 v[252:255], v29 offset:1504
v_cvt_pk_bf16_f32 v176, v64, v65
v_mfma_f32_32x32x16_bf16 v[32:47], a[200:203], a[4:7], v[32:47]
buffer_load_dwordx4 a[32:35], v26, s[76:79], s66 offen offset:0 sc1
ds_read_b64_tr_b16 a[220:221], v21 offset:43008
ds_read_b64_tr_b16 a[222:223], v21 offset:44032
v_mfma_f32_32x32x16_bf16 v[48:63], a[204:207], a[4:7], v[48:63]
buffer_load_dwordx4 a[36:39], v26, s[76:79], s66 offen offset:1024 sc1
v_fma_f32 v66, v130, v66, v194
s_waitcnt vmcnt(6) lgkmcnt(0)
v_mfma_f32_32x32x16_bf16 v[32:47], a[208:211], a[8:11], v[32:47]
s_barrier
ds_read_b64_tr_b16 a[192:193], v20 offset:45056
ds_read_b64_tr_b16 a[194:195], v20 offset:46080
v_fma_f32 v67, v131, v67, v195
v_mfma_f32_32x32x16_bf16 v[48:63], a[212:215], a[8:11], v[48:63]
ds_read_b64_tr_b16 a[196:197], v21 offset:45056
ds_read_b64_tr_b16 a[198:199], v21 offset:46080
ds_read_b64_tr_b16 a[200:201], v20 offset:47104
v_cvt_pk_bf16_f32 v177, v66, v67
v_fma_f32 v68, v132, v68, v196
v_fma_f32 v69, v133, v69, v197
v_mfma_f32_32x32x16_bf16 v[32:47], a[216:219], a[12:15], v[32:47]
buffer_load_dwordx4 a[40:43], v26, s[76:79], s66 offen offset:2048 sc1
ds_read_b64_tr_b16 a[202:203], v20 offset:48128
ds_read_b64_tr_b16 a[204:205], v21 offset:47104
ds_read_b64_tr_b16 a[206:207], v21 offset:48128
v_mfma_f32_32x32x16_bf16 v[48:63], a[220:223], a[12:15], v[48:63]
buffer_load_dwordx4 a[44:47], v26, s[76:79], s66 offen offset:3072 sc1
v_cvt_pk_bf16_f32 v178, v68, v69
s_waitcnt vmcnt(6) lgkmcnt(0)
v_mfma_f32_32x32x16_bf16 v[32:47], a[192:195], a[16:19], v[32:47]
ds_read_b64_tr_b16 a[208:209], v20 offset:49152
ds_read_b64_tr_b16 a[210:211], v20 offset:50176
ds_read_b64_tr_b16 a[212:213], v21 offset:49152
v_fma_f32 v70, v134, v70, v198
v_fma_f32 v71, v135, v71, v199
v_cvt_pk_bf16_f32 v179, v70, v71
v_mfma_f32_32x32x16_bf16 v[48:63], a[196:199], a[16:19], v[48:63]
ds_read_b64_tr_b16 a[214:215], v21 offset:50176
ds_read_b64_tr_b16 a[216:217], v20 offset:51200
ds_read_b64_tr_b16 a[218:219], v20 offset:52224
v_fma_f32 v72, v136, v72, v200
v_fma_f32 v73, v137, v73, v201
v_cvt_pk_bf16_f32 v180, v72, v73
v_mfma_f32_32x32x16_bf16 v[32:47], a[200:203], a[20:23], v[32:47]
s_add_u32 s43, s70, 16777216
s_add_u32 s43, s43, s93
s_cmp_lg_u32 s32, 0
s_cbranch_scc0 L_mr_st110x
buffer_store_dwordx4 v[176:179], v26, s[24:27], s43 offen offset:0
L_mr_st110j:
ds_read_b64_tr_b16 a[220:221], v21 offset:51200
ds_read_b64_tr_b16 a[222:223], v21 offset:52224
s_add_u32 m0, s41, 0
v_mfma_f32_32x32x16_bf16 v[48:63], a[204:207], a[20:23], v[48:63]
buffer_load_dwordx4 v9, s[16:19], s51 offen lds
v_fma_f32 v74, v138, v74, v202
s_waitcnt vmcnt(6) lgkmcnt(0)
v_mfma_f32_32x32x16_bf16 v[32:47], a[208:211], a[24:27], v[32:47]
ds_read_b64_tr_b16 a[192:193], v20 offset:53248
ds_read_b64_tr_b16 a[194:195], v20 offset:54272
ds_read_b64_tr_b16 a[196:197], v21 offset:53248
v_fma_f32 v75, v139, v75, v203
v_cvt_pk_bf16_f32 v181, v74, v75
v_fma_f32 v76, v140, v76, v204
v_mfma_f32_32x32x16_bf16 v[48:63], a[212:215], a[24:27], v[48:63]
ds_read_b64_tr_b16 a[198:199], v21 offset:54272
ds_read_b64_tr_b16 a[200:201], v20 offset:55296
ds_read_b64_tr_b16 a[202:203], v20 offset:56320
v_fma_f32 v77, v141, v77, v205
v_cvt_pk_bf16_f32 v182, v76, v77
v_fma_f32 v78, v142, v78, v206
v_mfma_f32_32x32x16_bf16 v[32:47], a[216:219], a[28:31], v[32:47]
buffer_load_dwordx4 a[48:51], v26, s[76:79], s67 offen offset:0 sc1
ds_read_b64_tr_b16 a[204:205], v21 offset:55296
ds_read_b64_tr_b16 a[206:207], v21 offset:56320
v_mfma_f32_32x32x16_bf16 v[48:63], a[220:223], a[28:31], v[48:63]
buffer_load_dwordx4 a[52:55], v26, s[76:79], s67 offen offset:1024 sc1
v_fma_f32 v79, v143, v79, v207
v_cvt_pk_bf16_f32 v183, v78, v79
s_waitcnt lgkmcnt(0)
v_mfma_f32_32x32x16_bf16 v[32:47], a[192:195], v[176:179], v[32:47]
ds_read_b64_tr_b16 a[208:209], v20 offset:57344
ds_read_b64_tr_b16 a[210:211], v20 offset:58368
ds_read_b64_tr_b16 a[212:213], v21 offset:57344
v_fma_f32 v80, v144, v80, v208
v_fma_f32 v81, v145, v81, v209
v_cvt_pk_bf16_f32 v184, v80, v81
v_mfma_f32_32x32x16_bf16 v[48:63], a[196:199], v[176:179], v[48:63]
ds_read_b64_tr_b16 a[214:215], v21 offset:58368
ds_read_b64_tr_b16 a[216:217], v20 offset:59392
ds_read_b64_tr_b16 a[218:219], v20 offset:60416
v_fma_f32 v82, v146, v82, v210
v_fma_f32 v83, v147, v83, v211
v_cvt_pk_bf16_f32 v185, v82, v83
v_mfma_f32_32x32x16_bf16 v[32:47], a[200:203], v[180:183], v[32:47]
s_cmp_lg_u32 s32, 0
s_cbranch_scc0 L_mr_st111x
buffer_store_dwordx4 v[180:183], v26, s[24:27], s43 offen offset:1024
L_mr_st111j:
ds_read_b64_tr_b16 a[220:221], v21 offset:59392
ds_read_b64_tr_b16 a[222:223], v21 offset:60416
s_add_u32 m0, s41, 4096
v_mfma_f32_32x32x16_bf16 v[48:63], a[204:207], v[180:183], v[48:63]
buffer_load_dwordx4 v11, s[16:19], s51 offen lds
v_fma_f32 v84, v148, v84, v212
v_fma_f32 v85, v149, v85, v213
v_cvt_pk_bf16_f32 v186, v84, v85
v_fma_f32 v86, v150, v86, v214
v_fma_f32 v87, v151, v87, v215
v_cvt_pk_bf16_f32 v187, v86, v87
v_fma_f32 v88, v152, v88, v216
v_fma_f32 v89, v153, v89, v217
v_cvt_pk_bf16_f32 v188, v88, v89
v_fma_f32 v90, v154, v90, v218
v_fma_f32 v91, v155, v91, v219
v_cvt_pk_bf16_f32 v189, v90, v91
v_fma_f32 v92, v156, v92, v220
v_fma_f32 v93, v157, v93, v221
v_cvt_pk_bf16_f32 v190, v92, v93
v_fma_f32 v94, v158, v94, v222
v_fma_f32 v95, v159, v95, v223
v_cvt_pk_bf16_f32 v191, v94, v95
s_waitcnt lgkmcnt(0)
v_mfma_f32_32x32x16_bf16 v[32:47], a[208:211], v[184:187], v[32:47]
ds_read_b64_tr_b16 a[192:193], v20 offset:61440
ds_read_b64_tr_b16 a[194:195], v20 offset:62464
ds_read_b64_tr_b16 a[196:197], v21 offset:61440
v_lshlrev_b32 v192, 16, v160
v_and_b32 v193, 0xffff0000, v160
v_mfma_f32_32x32x16_bf16 v[48:63], a[212:215], v[184:187], v[48:63]
ds_read_b64_tr_b16 a[198:199], v21 offset:62464
ds_read_b64_tr_b16 a[200:201], v20 offset:63488
ds_read_b64_tr_b16 a[202:203], v20 offset:64512
v_lshlrev_b32 v194, 16, v161
v_and_b32 v195, 0xffff0000, v161
v_mfma_f32_32x32x16_bf16 v[32:47], a[216:219], v[188:191], v[32:47]
s_cmp_lg_u32 s32, 0
s_cbranch_scc0 L_mr_st112x
buffer_store_dwordx4 v[184:187], v26, s[24:27], s43 offen offset:2048
L_mr_st112j:
ds_read_b64_tr_b16 a[204:205], v21 offset:63488
ds_read_b64_tr_b16 a[206:207], v21 offset:64512
v_mfma_f32_32x32x16_bf16 v[48:63], a[220:223], v[188:191], v[48:63]
s_cmp_lg_u32 s32, 0
s_cbranch_scc0 L_mr_st113x
buffer_store_dwordx4 v[188:191], v26, s[24:27], s43 offen offset:3072
L_mr_st113j:
s_waitcnt lgkmcnt(0)
v_mfma_f32_32x32x16_bf16 v[64:79], a[192:195], v[160:163], v[224:239]
ds_read_b64_tr_b16 a[208:209], v22 offset:0
ds_read_b64_tr_b16 a[210:211], v22 offset:1024
ds_read_b64_tr_b16 a[212:213], v23 offset:0
v_lshlrev_b32 v196, 16, v162
v_and_b32 v197, 0xffff0000, v162
v_mfma_f32_32x32x16_bf16 v[80:95], a[196:199], v[160:163], v[240:255]
ds_read_b64_tr_b16 a[214:215], v23 offset:1024
ds_read_b64_tr_b16 a[216:217], v22 offset:2048
ds_read_b64_tr_b16 a[218:219], v22 offset:3072
v_lshlrev_b32 v198, 16, v163
v_and_b32 v199, 0xffff0000, v163
v_mfma_f32_32x32x16_bf16 v[64:79], a[200:203], v[164:167], v[64:79]
buffer_load_dwordx4 a[56:59], v26, s[76:79], s67 offen offset:2048 sc1
ds_read_b64_tr_b16 a[220:221], v23 offset:2048
ds_read_b64_tr_b16 a[222:223], v23 offset:3072
v_mfma_f32_32x32x16_bf16 v[80:95], a[204:207], v[164:167], v[80:95]
buffer_load_dwordx4 a[60:63], v26, s[76:79], s67 offen offset:3072 sc1
s_waitcnt lgkmcnt(0)
v_mfma_f32_32x32x16_bf16 v[64:79], a[208:211], v[168:171], v[64:79]
s_barrier
ds_read_b64_tr_b16 a[192:193], v22 offset:4096
ds_read_b64_tr_b16 a[194:195], v22 offset:5120
v_mfma_f32_32x32x16_bf16 v[80:95], a[212:215], v[168:171], v[80:95]
ds_read_b64_tr_b16 a[196:197], v23 offset:4096
ds_read_b64_tr_b16 a[198:199], v23 offset:5120
ds_read_b64_tr_b16 a[200:201], v22 offset:6144
v_lshlrev_b32 v200, 16, v164
s_add_u32 m0, s41, 8192
v_mfma_f32_32x32x16_bf16 v[64:79], a[216:219], v[172:175], v[64:79]
buffer_load_dwordx4 v9, s[16:19], s52 offen lds
ds_read_b64_tr_b16 a[202:203], v22 offset:7168
ds_read_b64_tr_b16 a[204:205], v23 offset:6144
ds_read_b64_tr_b16 a[206:207], v23 offset:7168
v_mfma_f32_32x32x16_bf16 v[80:95], a[220:223], v[172:175], v[80:95]
buffer_load_dwordx4 a[64:67], v26, s[76:79], s68 offen offset:0 sc1
s_waitcnt lgkmcnt(0)
v_mfma_f32_32x32x16_bf16 v[64:79], a[192:195], v[176:179], v[64:79]
ds_read_b64_tr_b16 a[208:209], v22 offset:8192
ds_read_b64_tr_b16 a[210:211], v22 offset:9216
ds_read_b64_tr_b16 a[212:213], v23 offset:8192
v_and_b32 v201, 0xffff0000, v164
v_lshlrev_b32 v202, 16, v165
v_mfma_f32_32x32x16_bf16 v[80:95], a[196:199], v[176:179], v[80:95]
ds_read_b64_tr_b16 a[214:215], v23 offset:9216
ds_read_b64_tr_b16 a[216:217], v22 offset:10240
ds_read_b64_tr_b16 a[218:219], v22 offset:11264
v_and_b32 v203, 0xffff0000, v165
v_lshlrev_b32 v204, 16, v166
v_mfma_f32_32x32x16_bf16 v[64:79], a[200:203], v[180:183], v[64:79]
buffer_load_dwordx4 a[68:71], v26, s[76:79], s68 offen offset:1024 sc1
ds_read_b64_tr_b16 a[220:221], v23 offset:10240
ds_read_b64_tr_b16 a[222:223], v23 offset:11264
s_add_u32 m0, s41, 12288
v_mfma_f32_32x32x16_bf16 v[80:95], a[204:207], v[180:183], v[80:95]
buffer_load_dwordx4 v11, s[16:19], s52 offen lds
s_waitcnt lgkmcnt(0)
v_mfma_f32_32x32x16_bf16 v[64:79], a[208:211], v[184:187], v[64:79]
ds_read_b64_tr_b16 a[192:193], v22 offset:12288
ds_read_b64_tr_b16 a[194:195], v22 offset:13312
ds_read_b64_tr_b16 a[196:197], v23 offset:12288
v_and_b32 v205, 0xffff0000, v166
v_lshlrev_b32 v206, 16, v167
v_mfma_f32_32x32x16_bf16 v[80:95], a[212:215], v[184:187], v[80:95]
ds_read_b64_tr_b16 a[198:199], v23 offset:13312
ds_read_b64_tr_b16 a[200:201], v22 offset:14336
ds_read_b64_tr_b16 a[202:203], v22 offset:15360
v_and_b32 v207, 0xffff0000, v167
v_lshlrev_b32 v208, 16, v168
v_mfma_f32_32x32x16_bf16 v[64:79], a[216:219], v[188:191], v[64:79]
s_waitcnt vmcnt(6)
s_mov_b32 s44, 49152
s_cmp_lg_u32 s32, 0
s_cbranch_scc0 L_mr_fl3x
buffer_store_dwordx2 v[6:7], v31, s[24:27], s44 offen
L_mr_fl3j:
ds_read_b64_tr_b16 a[204:205], v23 offset:14336
ds_read_b64_tr_b16 a[206:207], v23 offset:15360
v_mfma_f32_32x32x16_bf16 v[80:95], a[220:223], v[188:191], v[80:95]
buffer_load_dwordx4 a[72:75], v26, s[76:79], s68 offen offset:2048 sc1
s_waitcnt lgkmcnt(0)
v_mfma_f32_32x32x16_bf16 v[32:47], a[192:195], a[32:35], v[32:47]
ds_read_b64_tr_b16 a[208:209], v22 offset:16384
ds_read_b64_tr_b16 a[210:211], v22 offset:17408
ds_read_b64_tr_b16 a[212:213], v23 offset:16384
v_and_b32 v209, 0xffff0000, v168
v_lshlrev_b32 v210, 16, v169
v_mfma_f32_32x32x16_bf16 v[48:63], a[196:199], a[32:35], v[48:63]
buffer_load_dwordx4 a[76:79], v26, s[76:79], s68 offen offset:3072 sc1
ds_read_b64_tr_b16 a[214:215], v23 offset:17408
ds_read_b64_tr_b16 a[216:217], v22 offset:18432
ds_read_b64_tr_b16 a[218:219], v22 offset:19456
s_add_u32 m0, s41, 16384
v_mfma_f32_32x32x16_bf16 v[32:47], a[200:203], a[36:39], v[32:47]
buffer_load_dwordx4 v9, s[16:19], s53 offen lds
ds_read_b64_tr_b16 a[220:221], v23 offset:18432
ds_read_b64_tr_b16 a[222:223], v23 offset:19456
v_mfma_f32_32x32x16_bf16 v[48:63], a[204:207], a[36:39], v[48:63]
buffer_load_dwordx4 a[80:83], v26, s[76:79], s69 offen offset:0 sc1
s_waitcnt lgkmcnt(0)
v_mfma_f32_32x32x16_bf16 v[32:47], a[208:211], a[40:43], v[32:47]
ds_read_b64_tr_b16 a[192:193], v22 offset:20480
ds_read_b64_tr_b16 a[194:195], v22 offset:21504
ds_read_b64_tr_b16 a[196:197], v23 offset:20480
v_and_b32 v211, 0xffff0000, v169
v_lshlrev_b32 v212, 16, v170
v_mfma_f32_32x32x16_bf16 v[48:63], a[212:215], a[40:43], v[48:63]
buffer_load_dwordx4 a[84:87], v26, s[76:79], s69 offen offset:1024 sc1
ds_read_b64_tr_b16 a[198:199], v23 offset:21504
ds_read_b64_tr_b16 a[200:201], v22 offset:22528
ds_read_b64_tr_b16 a[202:203], v22 offset:23552
s_add_u32 m0, s41, 20480
v_mfma_f32_32x32x16_bf16 v[32:47], a[216:219], a[44:47], v[32:47]
buffer_load_dwordx4 v11, s[16:19], s53 offen lds
ds_read_b64_tr_b16 a[204:205], v23 offset:22528
ds_read_b64_tr_b16 a[206:207], v23 offset:23552
v_mfma_f32_32x32x16_bf16 v[48:63], a[220:223], a[44:47], v[48:63]
buffer_load_dwordx4 a[88:91], v26, s[76:79], s69 offen offset:2048 sc1
s_waitcnt lgkmcnt(0)
v_mfma_f32_32x32x16_bf16 v[32:47], a[192:195], a[48:51], v[32:47]
ds_read_b64_tr_b16 a[208:209], v22 offset:24576
ds_read_b64_tr_b16 a[210:211], v22 offset:25600
ds_read_b64_tr_b16 a[212:213], v23 offset:24576
v_and_b32 v213, 0xffff0000, v170
v_lshlrev_b32 v214, 16, v171
v_mfma_f32_32x32x16_bf16 v[48:63], a[196:199], a[48:51], v[48:63]
s_mov_b32 s45, 49152
buffer_load_dwordx2 v[0:1], v30, s[24:27], s45 offen sc1
ds_read_b64_tr_b16 a[214:215], v23 offset:25600
ds_read_b64_tr_b16 a[216:217], v22 offset:26624
ds_read_b64_tr_b16 a[218:219], v22 offset:27648
v_mfma_f32_32x32x16_bf16 v[32:47], a[200:203], a[52:55], v[32:47]
buffer_load_dwordx4 a[92:95], v26, s[76:79], s69 offen offset:3072 sc1
ds_read_b64_tr_b16 a[220:221], v23 offset:26624
ds_read_b64_tr_b16 a[222:223], v23 offset:27648
s_add_u32 m0, s41, 24576
v_mfma_f32_32x32x16_bf16 v[48:63], a[204:207], a[52:55], v[48:63]
buffer_load_dwordx4 v8, s[16:19], s58 offen lds
s_waitcnt vmcnt(15) lgkmcnt(0)
v_mfma_f32_32x32x16_bf16 v[32:47], a[208:211], a[56:59], v[32:47]
s_barrier
ds_read_b64_tr_b16 a[192:193], v22 offset:28672
ds_read_b64_tr_b16 a[194:195], v22 offset:29696
s_add_u32 m0, s41, 28672
v_mfma_f32_32x32x16_bf16 v[48:63], a[212:215], a[56:59], v[48:63]
buffer_load_dwordx4 v10, s[16:19], s58 offen lds
ds_read_b64_tr_b16 a[196:197], v23 offset:28672
ds_read_b64_tr_b16 a[198:199], v23 offset:29696
ds_read_b64_tr_b16 a[200:201], v22 offset:30720
v_and_b32 v215, 0xffff0000, v171
s_add_u32 m0, s41, 114688
v_mfma_f32_32x32x16_bf16 v[32:47], a[216:219], a[60:63], v[32:47]
buffer_load_dwordx4 v8, s[16:19], s59 offen lds
ds_read_b64_tr_b16 a[202:203], v22 offset:31744
ds_read_b64_tr_b16 a[204:205], v23 offset:30720
ds_read_b64_tr_b16 a[206:207], v23 offset:31744
s_add_u32 m0, s41, 118784
v_mfma_f32_32x32x16_bf16 v[48:63], a[220:223], a[60:63], v[48:63]
buffer_load_dwordx4 v10, s[16:19], s59 offen lds
s_waitcnt vmcnt(15) lgkmcnt(0)
v_mfma_f32_32x32x16_bf16 v[32:47], a[192:195], a[64:67], v[32:47]
ds_read_b64_tr_b16 a[208:209], v22 offset:32768
ds_read_b64_tr_b16 a[210:211], v22 offset:33792
ds_read_b64_tr_b16 a[212:213], v23 offset:32768
v_lshlrev_b32 v216, 16, v172
v_and_b32 v217, 0xffff0000, v172
v_mfma_f32_32x32x16_bf16 v[48:63], a[196:199], a[64:67], v[48:63]
ds_read_b64_tr_b16 a[214:215], v23 offset:33792
ds_read_b64_tr_b16 a[216:217], v22 offset:34816
ds_read_b64_tr_b16 a[218:219], v22 offset:35840
v_lshlrev_b32 v218, 16, v173
s_add_u32 m0, s41, 126976
v_mfma_f32_32x32x16_bf16 v[32:47], a[200:203], a[68:71], v[32:47]
buffer_load_dwordx4 v8, s[16:19], s60 offen lds
ds_read_b64_tr_b16 a[220:221], v23 offset:34816
ds_read_b64_tr_b16 a[222:223], v23 offset:35840
s_add_u32 m0, s41, 131072
v_mfma_f32_32x32x16_bf16 v[48:63], a[204:207], a[68:71], v[48:63]
buffer_load_dwordx4 v10, s[16:19], s60 offen lds
s_waitcnt vmcnt(13) lgkmcnt(0)
v_mfma_f32_32x32x16_bf16 v[32:47], a[208:211], a[72:75], v[32:47]
ds_read_b64_tr_b16 a[192:193], v22 offset:36864
ds_read_b64_tr_b16 a[194:195], v22 offset:37888
ds_read_b64_tr_b16 a[196:197], v23 offset:36864
s_waitcnt vmcnt(7)
L_mr_sp11:
v_cmp_eq_u64 vcc, s[48:49], v[0:1]
s_nop 1
s_and_b32 s44, vcc_lo, 63
s_cmp_eq_u32 s44, 63
s_cbranch_scc0 L_mr_ok11x
L_mr_ok11:
v_mfma_f32_32x32x16_bf16 v[48:63], a[212:215], a[72:75], v[48:63]
ds_read_b64_tr_b16 a[198:199], v23 offset:37888
ds_read_b64_tr_b16 a[200:201], v22 offset:38912
ds_read_b64_tr_b16 a[202:203], v22 offset:39936
v_and_b32 v219, 0xffff0000, v173
s_add_u32 m0, s41, 139264
v_mfma_f32_32x32x16_bf16 v[32:47], a[216:219], a[76:79], v[32:47]
buffer_load_dwordx4 v8, s[16:19], s61 offen lds
ds_read_b64_tr_b16 a[204:205], v23 offset:38912
ds_read_b64_tr_b16 a[206:207], v23 offset:39936
v_mfma_f32_32x32x16_bf16 v[48:63], a[220:223], a[76:79], v[48:63]
buffer_load_dwordx4 a[96:99], v26, s[76:79], s71 offen offset:0 sc1
s_waitcnt lgkmcnt(0)
v_mfma_f32_32x32x16_bf16 v[32:47], a[192:195], a[80:83], v[32:47]
ds_read_b64_tr_b16 a[208:209], v22 offset:40960
ds_read_b64_tr_b16 a[210:211], v22 offset:41984
ds_read_b64_tr_b16 a[212:213], v23 offset:40960
v_lshlrev_b32 v220, 16, v174
v_and_b32 v221, 0xffff0000, v174
v_mfma_f32_32x32x16_bf16 v[48:63], a[196:199], a[80:83], v[48:63]
ds_read_b64_tr_b16 a[214:215], v23 offset:41984
ds_read_b64_tr_b16 a[216:217], v22 offset:43008
ds_read_b64_tr_b16 a[218:219], v22 offset:44032
v_lshlrev_b32 v222, 16, v175
v_and_b32 v223, 0xffff0000, v175
v_mfma_f32_32x32x16_bf16 v[32:47], a[200:203], a[84:87], v[32:47]
buffer_load_dwordx4 a[100:103], v26, s[76:79], s71 offen offset:1024 sc1
ds_read_b64_tr_b16 a[220:221], v23 offset:43008
ds_read_b64_tr_b16 a[222:223], v23 offset:44032
s_add_u32 m0, s41, 143360
v_mfma_f32_32x32x16_bf16 v[48:63], a[204:207], a[84:87], v[48:63]
buffer_load_dwordx4 v10, s[16:19], s61 offen lds
s_waitcnt vmcnt(10) lgkmcnt(0)
v_mfma_f32_32x32x16_bf16 v[32:47], a[208:211], a[88:91], v[32:47]
ds_read_b64_tr_b16 a[192:193], v20 offset:0
ds_read_b64_tr_b16 a[194:195], v20 offset:1024
ds_read_b64_tr_b16 a[196:197], v21 offset:0
v_mfma_f32_32x32x16_bf16 v[48:63], a[212:215], a[88:91], v[48:63]
ds_read_b64_tr_b16 a[198:199], v21 offset:1024
ds_read_b64_tr_b16 a[200:201], v20 offset:2048
ds_read_b64_tr_b16 a[202:203], v20 offset:3072
v_mfma_f32_32x32x16_bf16 v[32:47], a[216:219], a[92:95], v[32:47]
buffer_load_dwordx4 a[104:107], v26, s[76:79], s71 offen offset:2048 sc1
ds_read_b64_tr_b16 a[204:205], v21 offset:2048
ds_read_b64_tr_b16 a[206:207], v21 offset:3072
v_mfma_f32_32x32x16_bf16 v[48:63], a[220:223], a[92:95], v[48:63]
buffer_load_dwordx4 a[108:111], v26, s[76:79], s71 offen offset:3072 sc1
s_waitcnt lgkmcnt(0)
v_mfma_f32_32x32x16_bf16 v[64:79], a[192:195], a[0:3], v[64:79]
ds_read_b64_tr_b16 a[208:209], v20 offset:4096
ds_read_b64_tr_b16 a[210:211], v20 offset:5120
ds_read_b64_tr_b16 a[212:213], v21 offset:4096
v_mfma_f32_32x32x16_bf16 v[80:95], a[196:199], a[0:3], v[80:95]
ds_read_b64_tr_b16 a[214:215], v21 offset:5120
ds_read_b64_tr_b16 a[216:217], v20 offset:6144
ds_read_b64_tr_b16 a[218:219], v20 offset:7168
s_add_u32 m0, s41, 151552
v_mfma_f32_32x32x16_bf16 v[64:79], a[200:203], a[4:7], v[64:79]
buffer_load_dwordx4 v8, s[16:19], s62 offen lds
ds_read_b64_tr_b16 a[220:221], v21 offset:6144
ds_read_b64_tr_b16 a[222:223], v21 offset:7168
v_mfma_f32_32x32x16_bf16 v[80:95], a[204:207], a[4:7], v[80:95]
buffer_load_dwordx4 a[112:115], v26, s[76:79], s72 offen offset:0 sc1
s_waitcnt vmcnt(12) lgkmcnt(0)
v_mfma_f32_32x32x16_bf16 v[64:79], a[208:211], a[8:11], v[64:79]
s_barrier
ds_read_b64_tr_b16 a[192:193], v20 offset:8192
ds_read_b64_tr_b16 a[194:195], v20 offset:9216
v_mfma_f32_32x32x16_bf16 v[80:95], a[212:215], a[8:11], v[80:95]
ds_read_b64_tr_b16 a[196:197], v21 offset:8192
ds_read_b64_tr_b16 a[198:199], v21 offset:9216
ds_read_b64_tr_b16 a[200:201], v20 offset:10240
v_mfma_f32_32x32x16_bf16 v[64:79], a[216:219], a[12:15], v[64:79]
buffer_load_dwordx4 a[116:119], v26, s[76:79], s72 offen offset:1024 sc1
ds_read_b64_tr_b16 a[202:203], v20 offset:11264
ds_read_b64_tr_b16 a[204:205], v21 offset:10240
ds_read_b64_tr_b16 a[206:207], v21 offset:11264
s_add_u32 m0, s41, 155648
v_mfma_f32_32x32x16_bf16 v[80:95], a[220:223], a[12:15], v[80:95]
buffer_load_dwordx4 v10, s[16:19], s62 offen lds
s_waitcnt lgkmcnt(0)
v_mfma_f32_32x32x16_bf16 v[64:79], a[192:195], a[16:19], v[64:79]
ds_read_b64_tr_b16 a[208:209], v20 offset:12288
ds_read_b64_tr_b16 a[210:211], v20 offset:13312
ds_read_b64_tr_b16 a[212:213], v21 offset:12288
v_mfma_f32_32x32x16_bf16 v[80:95], a[196:199], a[16:19], v[80:95]
ds_read_b64_tr_b16 a[214:215], v21 offset:13312
ds_read_b64_tr_b16 a[216:217], v20 offset:14336
ds_read_b64_tr_b16 a[218:219], v20 offset:15360
v_mfma_f32_32x32x16_bf16 v[64:79], a[200:203], a[20:23], v[64:79]
buffer_load_dwordx4 a[120:123], v26, s[76:79], s72 offen offset:2048 sc1
ds_read_b64_tr_b16 a[220:221], v21 offset:14336
ds_read_b64_tr_b16 a[222:223], v21 offset:15360
v_mfma_f32_32x32x16_bf16 v[80:95], a[204:207], a[20:23], v[80:95]
buffer_load_dwordx4 a[124:127], v26, s[76:79], s72 offen offset:3072 sc1
s_waitcnt lgkmcnt(0)
v_mfma_f32_32x32x16_bf16 v[64:79], a[208:211], a[24:27], v[64:79]
ds_read_b64_tr_b16 a[192:193], v20 offset:16384
ds_read_b64_tr_b16 a[194:195], v20 offset:17408
ds_read_b64_tr_b16 a[196:197], v21 offset:16384
v_mfma_f32_32x32x16_bf16 v[80:95], a[212:215], a[24:27], v[80:95]
ds_read_b64_tr_b16 a[198:199], v21 offset:17408
ds_read_b64_tr_b16 a[200:201], v20 offset:18432
ds_read_b64_tr_b16 a[202:203], v20 offset:19456
s_add_u32 m0, s41, 32768
v_mfma_f32_32x32x16_bf16 v[64:79], a[216:219], a[28:31], v[64:79]
buffer_load_dwordx4 v9, s[16:19], s54 offen lds
ds_read_b64_tr_b16 a[204:205], v21 offset:18432
ds_read_b64_tr_b16 a[206:207], v21 offset:19456
v_mfma_f32_32x32x16_bf16 v[80:95], a[220:223], a[28:31], v[80:95]
buffer_load_dwordx4 a[128:131], v26, s[76:79], s73 offen offset:0 sc1
s_waitcnt lgkmcnt(0)
v_mfma_f32_32x32x16_bf16 v[64:79], a[192:195], a[32:35], v[64:79]
ds_read_b64_tr_b16 a[208:209], v20 offset:20480
ds_read_b64_tr_b16 a[210:211], v20 offset:21504
ds_read_b64_tr_b16 a[212:213], v21 offset:20480
v_mfma_f32_32x32x16_bf16 v[80:95], a[196:199], a[32:35], v[80:95]
ds_read_b64_tr_b16 a[214:215], v21 offset:21504
ds_read_b64_tr_b16 a[216:217], v20 offset:22528
ds_read_b64_tr_b16 a[218:219], v20 offset:23552
v_mfma_f32_32x32x16_bf16 v[64:79], a[200:203], a[36:39], v[64:79]
buffer_load_dwordx4 a[132:135], v26, s[76:79], s73 offen offset:1024 sc1
ds_read_b64_tr_b16 a[220:221], v21 offset:22528
ds_read_b64_tr_b16 a[222:223], v21 offset:23552
s_add_u32 m0, s41, 36864
v_mfma_f32_32x32x16_bf16 v[80:95], a[204:207], a[36:39], v[80:95]
buffer_load_dwordx4 v11, s[16:19], s54 offen lds
s_waitcnt lgkmcnt(0)
v_mfma_f32_32x32x16_bf16 v[64:79], a[208:211], a[40:43], v[64:79]
ds_read_b64_tr_b16 a[192:193], v20 offset:24576
ds_read_b64_tr_b16 a[194:195], v20 offset:25600
ds_read_b64_tr_b16 a[196:197], v21 offset:24576
v_mfma_f32_32x32x16_bf16 v[80:95], a[212:215], a[40:43], v[80:95]
ds_read_b64_tr_b16 a[198:199], v21 offset:25600
ds_read_b64_tr_b16 a[200:201], v20 offset:26624
ds_read_b64_tr_b16 a[202:203], v20 offset:27648
v_mfma_f32_32x32x16_bf16 v[64:79], a[216:219], a[44:47], v[64:79]
buffer_load_dwordx4 a[136:139], v26, s[76:79], s73 offen offset:2048 sc1
ds_read_b64_tr_b16 a[204:205], v21 offset:26624
ds_read_b64_tr_b16 a[206:207], v21 offset:27648
v_mfma_f32_32x32x16_bf16 v[80:95], a[220:223], a[44:47], v[80:95]
buffer_load_dwordx4 a[140:143], v26, s[76:79], s73 offen offset:3072 sc1
s_waitcnt vmcnt(15) lgkmcnt(0)
v_mfma_f32_32x32x16_bf16 v[32:47], a[192:195], a[96:99], v[32:47]
ds_read_b64_tr_b16 a[208:209], v20 offset:28672
ds_read_b64_tr_b16 a[210:211], v20 offset:29696
ds_read_b64_tr_b16 a[212:213], v21 offset:28672
s_add_u32 m0, s41, 40960
v_mfma_f32_32x32x16_bf16 v[48:63], a[196:199], a[96:99], v[48:63]
buffer_load_dwordx4 v9, s[16:19], s55 offen lds
ds_read_b64_tr_b16 a[214:215], v21 offset:29696
ds_read_b64_tr_b16 a[216:217], v20 offset:30720
ds_read_b64_tr_b16 a[218:219], v20 offset:31744
v_mfma_f32_32x32x16_bf16 v[32:47], a[200:203], a[100:103], v[32:47]
buffer_load_dwordx4 a[144:147], v26, s[76:79], s74 offen offset:0 sc1
ds_read_b64_tr_b16 a[220:221], v21 offset:30720
ds_read_b64_tr_b16 a[222:223], v21 offset:31744
v_mfma_f32_32x32x16_bf16 v[48:63], a[204:207], a[100:103], v[48:63]
buffer_load_dwordx4 a[148:151], v26, s[76:79], s74 offen offset:1024 sc1
s_waitcnt vmcnt(15) lgkmcnt(0)
v_mfma_f32_32x32x16_bf16 v[32:47], a[208:211], a[104:107], v[32:47]
s_barrier
ds_read_b64_tr_b16 a[192:193], v22 offset:49152
ds_read_b64_tr_b16 a[194:195], v22 offset:50176
s_add_u32 m0, s41, 45056
v_mfma_f32_32x32x16_bf16 v[48:63], a[212:215], a[104:107], v[48:63]
buffer_load_dwordx4 v11, s[16:19], s55 offen lds
ds_read_b64_tr_b16 a[196:197], v23 offset:49152
ds_read_b64_tr_b16 a[198:199], v23 offset:50176
ds_read_b64_tr_b16 a[200:201], v22 offset:51200
v_mfma_f32_32x32x16_bf16 v[32:47], a[216:219], a[108:111], v[32:47]
buffer_load_dwordx4 a[152:155], v26, s[76:79], s74 offen offset:2048 sc1
ds_read_b64_tr_b16 a[202:203], v22 offset:52224
ds_read_b64_tr_b16 a[204:205], v23 offset:51200
ds_read_b64_tr_b16 a[206:207], v23 offset:52224
v_mfma_f32_32x32x16_bf16 v[48:63], a[220:223], a[108:111], v[48:63]
buffer_load_dwordx4 a[156:159], v26, s[76:79], s74 offen offset:3072 sc1
s_waitcnt vmcnt(15) lgkmcnt(0)
v_mfma_f32_32x32x16_bf16 v[32:47], a[192:195], a[112:115], v[32:47]
ds_read_b64_tr_b16 a[208:209], v22 offset:53248
ds_read_b64_tr_b16 a[210:211], v22 offset:54272
ds_read_b64_tr_b16 a[212:213], v23 offset:53248
s_add_u32 m0, s41, 49152
v_mfma_f32_32x32x16_bf16 v[48:63], a[196:199], a[112:115], v[48:63]
buffer_load_dwordx4 v9, s[16:19], s56 offen lds
ds_read_b64_tr_b16 a[214:215], v23 offset:54272
ds_read_b64_tr_b16 a[216:217], v22 offset:55296
ds_read_b64_tr_b16 a[218:219], v22 offset:56320
v_mfma_f32_32x32x16_bf16 v[32:47], a[200:203], a[116:119], v[32:47]
buffer_load_dwordx4 a[160:163], v26, s[76:79], s75 offen offset:0 sc1
ds_read_b64_tr_b16 a[220:221], v23 offset:55296
ds_read_b64_tr_b16 a[222:223], v23 offset:56320
v_mfma_f32_32x32x16_bf16 v[48:63], a[204:207], a[116:119], v[48:63]
buffer_load_dwordx4 a[164:167], v26, s[76:79], s75 offen offset:1024 sc1
s_waitcnt vmcnt(15) lgkmcnt(0)
v_mfma_f32_32x32x16_bf16 v[32:47], a[208:211], a[120:123], v[32:47]
ds_read_b64_tr_b16 a[192:193], v22 offset:61440
ds_read_b64_tr_b16 a[194:195], v22 offset:62464
ds_read_b64_tr_b16 a[196:197], v23 offset:61440
s_add_u32 m0, s41, 53248
v_mfma_f32_32x32x16_bf16 v[48:63], a[212:215], a[120:123], v[48:63]
buffer_load_dwordx4 v11, s[16:19], s56 offen lds
ds_read_b64_tr_b16 a[198:199], v23 offset:62464
ds_read_b64_tr_b16 a[200:201], v22 offset:63488
ds_read_b64_tr_b16 a[202:203], v22 offset:64512
v_mfma_f32_32x32x16_bf16 v[32:47], a[216:219], a[124:127], v[32:47]
buffer_load_dwordx4 a[168:171], v26, s[76:79], s75 offen offset:2048 sc1
ds_read_b64_tr_b16 a[204:205], v23 offset:63488
ds_read_b64_tr_b16 a[206:207], v23 offset:64512
v_mfma_f32_32x32x16_bf16 v[48:63], a[220:223], a[124:127], v[48:63]
buffer_load_dwordx4 a[172:175], v26, s[76:79], s75 offen offset:3072 sc1
s_waitcnt vmcnt(15) lgkmcnt(0)
v_mfma_f32_32x32x16_bf16 v[32:47], a[192:195], a[128:131], v[32:47]
ds_read_b64_tr_b16 a[208:209], v24 offset:0
ds_read_b64_tr_b16 a[210:211], v24 offset:1024
ds_read_b64_tr_b16 a[212:213], v25 offset:0
s_add_u32 m0, s41, 57344
v_mfma_f32_32x32x16_bf16 v[48:63], a[196:199], a[128:131], v[48:63]
buffer_load_dwordx4 v9, s[16:19], s58 offen lds
ds_read_b64_tr_b16 a[214:215], v25 offset:1024
ds_read_b64_tr_b16 a[216:217], v24 offset:2048
ds_read_b64_tr_b16 a[218:219], v24 offset:3072
s_add_u32 m0, s41, 61440
v_mfma_f32_32x32x16_bf16 v[32:47], a[200:203], a[132:135], v[32:47]
buffer_load_dwordx4 v11, s[16:19], s58 offen lds
ds_read_b64_tr_b16 a[220:221], v25 offset:2048
ds_read_b64_tr_b16 a[222:223], v25 offset:3072
s_add_u32 m0, s41, 65536
v_mfma_f32_32x32x16_bf16 v[48:63], a[204:207], a[132:135], v[48:63]
buffer_load_dwordx4 v9, s[16:19], s59 offen lds
s_waitcnt vmcnt(15) lgkmcnt(0)
v_mfma_f32_32x32x16_bf16 v[32:47], a[208:211], a[136:139], v[32:47]
ds_read_b64_tr_b16 a[192:193], v24 offset:8192
ds_read_b64_tr_b16 a[194:195], v24 offset:9216
ds_read_b64_tr_b16 a[196:197], v25 offset:8192
v_mfma_f32_32x32x16_bf16 v[48:63], a[212:215], a[136:139], v[48:63]
ds_read_b64_tr_b16 a[198:199], v25 offset:9216
ds_read_b64_tr_b16 a[200:201], v24 offset:10240
ds_read_b64_tr_b16 a[202:203], v24 offset:11264
s_add_u32 m0, s41, 69632
v_mfma_f32_32x32x16_bf16 v[32:47], a[216:219], a[140:143], v[32:47]
buffer_load_dwordx4 v11, s[16:19], s59 offen lds
ds_read_b64_tr_b16 a[204:205], v25 offset:10240
ds_read_b64_tr_b16 a[206:207], v25 offset:11264
s_add_u32 m0, s41, 73728
v_mfma_f32_32x32x16_bf16 v[48:63], a[220:223], a[140:143], v[48:63]
buffer_load_dwordx4 v9, s[16:19], s60 offen lds
s_waitcnt vmcnt(14) lgkmcnt(0)
v_mfma_f32_32x32x16_bf16 v[32:47], a[192:195], a[144:147], v[32:47]
ds_read_b64_tr_b16 a[208:209], v24 offset:12288
ds_read_b64_tr_b16 a[210:211], v24 offset:13312
ds_read_b64_tr_b16 a[212:213], v25 offset:12288
v_mfma_f32_32x32x16_bf16 v[48:63], a[196:199], a[144:147], v[48:63]
ds_read_b64_tr_b16 a[214:215], v25 offset:13312
ds_read_b64_tr_b16 a[216:217], v24 offset:14336
ds_read_b64_tr_b16 a[218:219], v24 offset:15360
s_add_u32 m0, s41, 77824
v_mfma_f32_32x32x16_bf16 v[32:47], a[200:203], a[148:151], v[32:47]
buffer_load_dwordx4 v11, s[16:19], s60 offen lds
ds_read_b64_tr_b16 a[220:221], v25 offset:14336
ds_read_b64_tr_b16 a[222:223], v25 offset:15360
s_add_u32 m0, s41, 81920
v_mfma_f32_32x32x16_bf16 v[48:63], a[204:207], a[148:151], v[48:63]
buffer_load_dwordx4 v9, s[16:19], s61 offen lds
s_waitcnt vmcnt(13) lgkmcnt(0)
v_mfma_f32_32x32x16_bf16 v[32:47], a[208:211], a[152:155], v[32:47]
s_barrier
ds_read_b64_tr_b16 a[192:193], v24 offset:20480
ds_read_b64_tr_b16 a[194:195], v24 offset:21504
v_mfma_f32_32x32x16_bf16 v[48:63], a[212:215], a[152:155], v[48:63]
ds_read_b64_tr_b16 a[196:197], v25 offset:20480
ds_read_b64_tr_b16 a[198:199], v25 offset:21504
ds_read_b64_tr_b16 a[200:201], v24 offset:22528
s_add_u32 m0, s41, 86016
v_mfma_f32_32x32x16_bf16 v[32:47], a[216:219], a[156:159], v[32:47]
buffer_load_dwordx4 v11, s[16:19], s61 offen lds
ds_read_b64_tr_b16 a[202:203], v24 offset:23552
ds_read_b64_tr_b16 a[204:205], v25 offset:22528
ds_read_b64_tr_b16 a[206:207], v25 offset:23552
s_add_u32 m0, s41, 90112
v_mfma_f32_32x32x16_bf16 v[48:63], a[220:223], a[156:159], v[48:63]
buffer_load_dwordx4 v9, s[16:19], s62 offen lds
s_waitcnt vmcnt(12) lgkmcnt(0)
v_mfma_f32_32x32x16_bf16 v[32:47], a[192:195], a[160:163], v[32:47]
ds_read_b64_tr_b16 a[208:209], v24 offset:24576
ds_read_b64_tr_b16 a[210:211], v24 offset:25600
ds_read_b64_tr_b16 a[212:213], v25 offset:24576
v_mfma_f32_32x32x16_bf16 v[48:63], a[196:199], a[160:163], v[48:63]
ds_read_b64_tr_b16 a[214:215], v25 offset:25600
ds_read_b64_tr_b16 a[216:217], v24 offset:26624
ds_read_b64_tr_b16 a[218:219], v24 offset:27648
s_add_u32 m0, s41, 94208
v_mfma_f32_32x32x16_bf16 v[32:47], a[200:203], a[164:167], v[32:47]
buffer_load_dwordx4 v11, s[16:19], s62 offen lds
ds_read_b64_tr_b16 a[220:221], v25 offset:26624
ds_read_b64_tr_b16 a[222:223], v25 offset:27648
v_mfma_f32_32x32x16_bf16 v[48:63], a[204:207], a[164:167], v[48:63]
s_waitcnt vmcnt(10) lgkmcnt(0)
v_mfma_f32_32x32x16_bf16 v[32:47], a[208:211], a[168:171], v[32:47]
ds_read_b64_tr_b16 a[192:193], v20 offset:32768
ds_read_b64_tr_b16 a[194:195], v20 offset:33792
ds_read_b64_tr_b16 a[196:197], v21 offset:32768
v_mfma_f32_32x32x16_bf16 v[48:63], a[212:215], a[168:171], v[48:63]
ds_read_b64_tr_b16 a[198:199], v21 offset:33792
ds_read_b64_tr_b16 a[200:201], v20 offset:34816
ds_read_b64_tr_b16 a[202:203], v20 offset:35840
v_mfma_f32_32x32x16_bf16 v[32:47], a[216:219], a[172:175], v[32:47]
ds_read_b64_tr_b16 a[204:205], v21 offset:34816
ds_read_b64_tr_b16 a[206:207], v21 offset:35840
v_mfma_f32_32x32x16_bf16 v[48:63], a[220:223], a[172:175], v[48:63]
s_waitcnt lgkmcnt(0)
v_mfma_f32_32x32x16_bf16 v[64:79], a[192:195], a[48:51], v[64:79]
ds_read_b64_tr_b16 a[208:209], v20 offset:36864
ds_read_b64_tr_b16 a[210:211], v20 offset:37888
ds_read_b64_tr_b16 a[212:213], v21 offset:36864
v_mfma_f32_32x32x16_bf16 v[80:95], a[196:199], a[48:51], v[80:95]
ds_read_b64_tr_b16 a[214:215], v21 offset:37888
ds_read_b64_tr_b16 a[216:217], v20 offset:38912
ds_read_b64_tr_b16 a[218:219], v20 offset:39936
v_fma_f32 v32, v96, v32, v192
v_fma_f32 v33, v97, v33, v193
v_cvt_pk_bf16_f32 v160, v32, v33
v_mfma_f32_32x32x16_bf16 v[64:79], a[200:203], a[52:55], v[64:79]
ds_read_b64_tr_b16 a[220:221], v21 offset:38912
ds_read_b64_tr_b16 a[222:223], v21 offset:39936
v_fma_f32 v34, v98, v34, v194
v_fma_f32 v35, v99, v35, v195
v_cvt_pk_bf16_f32 v161, v34, v35
v_fma_f32 v36, v100, v36, v196
v_mfma_f32_32x32x16_bf16 v[80:95], a[204:207], a[52:55], v[80:95]
v_fma_f32 v37, v101, v37, v197
v_cvt_pk_bf16_f32 v162, v36, v37
v_fma_f32 v38, v102, v38, v198
v_fma_f32 v39, v103, v39, v199
v_cvt_pk_bf16_f32 v163, v38, v39
s_waitcnt lgkmcnt(0)
v_mfma_f32_32x32x16_bf16 v[64:79], a[208:211], a[56:59], v[64:79]
ds_read_b64_tr_b16 a[192:193], v20 offset:40960
ds_read_b64_tr_b16 a[194:195], v20 offset:41984
ds_read_b64_tr_b16 a[196:197], v21 offset:40960
v_fma_f32 v40, v104, v40, v200
v_fma_f32 v41, v105, v41, v201
v_cvt_pk_bf16_f32 v164, v40, v41
v_mfma_f32_32x32x16_bf16 v[80:95], a[212:215], a[56:59], v[80:95]
ds_read_b64_tr_b16 a[198:199], v21 offset:41984
ds_read_b64_tr_b16 a[200:201], v20 offset:43008
ds_read_b64_tr_b16 a[202:203], v20 offset:44032
v_fma_f32 v42, v106, v42, v202
v_fma_f32 v43, v107, v43, v203
v_cvt_pk_bf16_f32 v165, v42, v43
v_mfma_f32_32x32x16_bf16 v[64:79], a[216:219], a[60:63], v[64:79]
ds_read_b64_tr_b16 a[204:205], v21 offset:43008
ds_read_b64_tr_b16 a[206:207], v21 offset:44032
v_fma_f32 v44, v108, v44, v204
v_fma_f32 v45, v109, v45, v205
v_cvt_pk_bf16_f32 v166, v44, v45
v_fma_f32 v46, v110, v46, v206
v_mfma_f32_32x32x16_bf16 v[80:95], a[220:223], a[60:63], v[80:95]
v_fma_f32 v47, v111, v47, v207
v_cvt_pk_bf16_f32 v167, v46, v47
v_fma_f32 v48, v112, v48, v208
v_fma_f32 v49, v113, v49, v209
v_cvt_pk_bf16_f32 v168, v48, v49
s_waitcnt lgkmcnt(0)
v_mfma_f32_32x32x16_bf16 v[64:79], a[192:195], a[64:67], v[64:79]
ds_read_b64_tr_b16 a[208:209], v20 offset:45056
ds_read_b64_tr_b16 a[210:211], v20 offset:46080
ds_read_b64_tr_b16 a[212:213], v21 offset:45056
v_fma_f32 v50, v114, v50, v210
v_fma_f32 v51, v115, v51, v211
v_cvt_pk_bf16_f32 v169, v50, v51
v_mfma_f32_32x32x16_bf16 v[80:95], a[196:199], a[64:67], v[80:95]
ds_read_b64_tr_b16 a[214:215], v21 offset:46080
ds_read_b64_tr_b16 a[216:217], v20 offset:47104
ds_read_b64_tr_b16 a[218:219], v20 offset:48128
v_fma_f32 v52, v116, v52, v212
v_fma_f32 v53, v117, v53, v213
v_cvt_pk_bf16_f32 v170, v52, v53
v_mfma_f32_32x32x16_bf16 v[64:79], a[200:203], a[68:71], v[64:79]
ds_read_b64_tr_b16 a[220:221], v21 offset:47104
ds_read_b64_tr_b16 a[222:223], v21 offset:48128
v_fma_f32 v54, v118, v54, v214
v_fma_f32 v55, v119, v55, v215
v_cvt_pk_bf16_f32 v171, v54, v55
v_fma_f32 v56, v120, v56, v216
v_mfma_f32_32x32x16_bf16 v[80:95], a[204:207], a[68:71], v[80:95]
v_fma_f32 v57, v121, v57, v217
v_cvt_pk_bf16_f32 v172, v56, v57
v_fma_f32 v58, v122, v58, v218
v_fma_f32 v59, v123, v59, v219
v_cvt_pk_bf16_f32 v173, v58, v59
s_waitcnt vmcnt(6) lgkmcnt(0)
v_mfma_f32_32x32x16_bf16 v[64:79], a[208:211], a[72:75], v[64:79]
s_barrier
ds_read_b64_tr_b16 a[192:193], v20 offset:49152
ds_read_b64_tr_b16 a[194:195], v20 offset:50176
v_fma_f32 v60, v124, v60, v220
v_mfma_f32_32x32x16_bf16 v[80:95], a[212:215], a[72:75], v[80:95]
ds_read_b64_tr_b16 a[196:197], v21 offset:49152
ds_read_b64_tr_b16 a[198:199], v21 offset:50176
ds_read_b64_tr_b16 a[200:201], v20 offset:51200
v_fma_f32 v61, v125, v61, v221
v_cvt_pk_bf16_f32 v174, v60, v61
v_fma_f32 v62, v126, v62, v222
v_mfma_f32_32x32x16_bf16 v[64:79], a[216:219], a[76:79], v[64:79]
ds_read_b64_tr_b16 a[202:203], v20 offset:52224
ds_read_b64_tr_b16 a[204:205], v21 offset:51200
ds_read_b64_tr_b16 a[206:207], v21 offset:52224
v_fma_f32 v63, v127, v63, v223
v_cvt_pk_bf16_f32 v175, v62, v63
v_mfma_f32_32x32x16_bf16 v[80:95], a[220:223], a[76:79], v[80:95]
v_lshlrev_b32 v192, 16, v176
v_subrev_u32 v16, s35, v26
v_add_u32 v16, s47, v16
v_xor_b32 v96, 0, v27
v_lshl_add_u32 v96, v96, 4, v28
ds_write_b64 v96, v[160:161]
s_waitcnt lgkmcnt(1)
v_mfma_f32_32x32x16_bf16 v[64:79], a[192:195], a[80:83], v[64:79]
ds_read_b64_tr_b16 a[208:209], v20 offset:53248
ds_read_b64_tr_b16 a[210:211], v20 offset:54272
ds_read_b64_tr_b16 a[212:213], v21 offset:53248
v_and_b32 v193, 0xffff0000, v176
v_xor_b32 v98, 1, v27
v_lshl_add_u32 v98, v98, 4, v28
ds_write_b64 v98, v[162:163]
v_mfma_f32_32x32x16_bf16 v[80:95], a[196:199], a[80:83], v[80:95]
ds_read_b64_tr_b16 a[214:215], v21 offset:54272
ds_read_b64_tr_b16 a[216:217], v20 offset:55296
ds_read_b64_tr_b16 a[218:219], v20 offset:56320
v_xor_b32 v100, 2, v27
v_lshl_add_u32 v100, v100, 4, v28
ds_write_b64 v100, v[164:165]
v_mfma_f32_32x32x16_bf16 v[64:79], a[200:203], a[84:87], v[64:79]
ds_read_b64_tr_b16 a[220:221], v21 offset:55296
ds_read_b64_tr_b16 a[222:223], v21 offset:56320
v_lshlrev_b32 v194, 16, v177
v_xor_b32 v102, 3, v27
v_lshl_add_u32 v102, v102, 4, v28
ds_write_b64 v102, v[166:167]
v_mfma_f32_32x32x16_bf16 v[80:95], a[204:207], a[84:87], v[80:95]
v_and_b32 v195, 0xffff0000, v177
v_xor_b32 v104, 4, v27
v_lshl_add_u32 v104, v104, 4, v28
ds_write_b64 v104, v[168:169]
s_waitcnt lgkmcnt(2)
v_mfma_f32_32x32x16_bf16 v[64:79], a[208:211], a[88:91], v[64:79]
ds_read_b64_tr_b16 a[192:193], v20 offset:57344
ds_read_b64_tr_b16 a[194:195], v20 offset:58368
ds_read_b64_tr_b16 a[196:197], v21 offset:57344
v_lshlrev_b32 v196, 16, v178
v_xor_b32 v106, 5, v27
v_lshl_add_u32 v106, v106, 4, v28
ds_write_b64 v106, v[170:171]
v_mfma_f32_32x32x16_bf16 v[80:95], a[212:215], a[88:91], v[80:95]
ds_read_b64_tr_b16 a[198:199], v21 offset:58368
ds_read_b64_tr_b16 a[200:201], v20 offset:59392
ds_read_b64_tr_b16 a[202:203], v20 offset:60416
v_xor_b32 v108, 6, v27
v_lshl_add_u32 v108, v108, 4, v28
ds_write_b64 v108, v[172:173]
v_mfma_f32_32x32x16_bf16 v[64:79], a[216:219], a[92:95], v[64:79]
ds_read_b64_tr_b16 a[204:205], v21 offset:59392
ds_read_b64_tr_b16 a[206:207], v21 offset:60416
v_and_b32 v197, 0xffff0000, v178
v_xor_b32 v110, 7, v27
v_lshl_add_u32 v110, v110, 4, v28
ds_write_b64 v110, v[174:175]
v_mfma_f32_32x32x16_bf16 v[80:95], a[220:223], a[92:95], v[80:95]
v_lshlrev_b32 v198, 16, v179
v_and_b32 v199, 0xffff0000, v179
v_lshlrev_b32 v200, 16, v180
v_and_b32 v201, 0xffff0000, v180
s_waitcnt lgkmcnt(1)
v_mfma_f32_32x32x16_bf16 v[64:79], a[192:195], a[96:99], v[64:79]
ds_read_b64_tr_b16 a[208:209], v20 offset:61440
ds_read_b64_tr_b16 a[210:211], v20 offset:62464
ds_read_b64_tr_b16 a[212:213], v21 offset:61440
v_lshlrev_b32 v202, 16, v181
v_and_b32 v203, 0xffff0000, v181
v_mfma_f32_32x32x16_bf16 v[80:95], a[196:199], a[96:99], v[80:95]
ds_read_b64_tr_b16 a[214:215], v21 offset:62464
ds_read_b64_tr_b16 a[216:217], v20 offset:63488
ds_read_b64_tr_b16 a[218:219], v20 offset:64512
v_lshlrev_b32 v204, 16, v182
v_and_b32 v205, 0xffff0000, v182
v_mfma_f32_32x32x16_bf16 v[64:79], a[200:203], a[100:103], v[64:79]
ds_read_b64_tr_b16 a[220:221], v21 offset:63488
ds_read_b64_tr_b16 a[222:223], v21 offset:64512
v_lshlrev_b32 v206, 16, v183
v_and_b32 v207, 0xffff0000, v183
v_lshlrev_b32 v208, 16, v184
v_mfma_f32_32x32x16_bf16 v[80:95], a[204:207], a[100:103], v[80:95]
v_and_b32 v209, 0xffff0000, v184
v_lshlrev_b32 v210, 16, v185
v_and_b32 v211, 0xffff0000, v185
v_lshlrev_b32 v212, 16, v186
s_waitcnt lgkmcnt(0)
v_mfma_f32_32x32x16_bf16 v[64:79], a[208:211], a[104:107], v[64:79]
ds_read_b64_tr_b16 a[192:193], v22 offset:0
ds_read_b64_tr_b16 a[194:195], v22 offset:1024
ds_read_b64_tr_b16 a[196:197], v23 offset:0
ds_read_b128 v[224:227], v16 offset:0
ds_read_b128 v[228:231], v16 offset:1024
v_mfma_f32_32x32x16_bf16 v[80:95], a[212:215], a[104:107], v[80:95]
ds_read_b64_tr_b16 a[198:199], v23 offset:1024
ds_read_b64_tr_b16 a[200:201], v22 offset:2048
ds_read_b64_tr_b16 a[202:203], v22 offset:3072
v_and_b32 v213, 0xffff0000, v186
ds_read_b128 v[232:235], v16 offset:2048
v_mfma_f32_32x32x16_bf16 v[64:79], a[216:219], a[108:111], v[64:79]
ds_read_b64_tr_b16 a[204:205], v23 offset:2048
ds_read_b64_tr_b16 a[206:207], v23 offset:3072
ds_read_b128 v[236:239], v16 offset:3072
v_lshlrev_b32 v214, 16, v187
v_and_b32 v215, 0xffff0000, v187
v_mfma_f32_32x32x16_bf16 v[80:95], a[220:223], a[108:111], v[80:95]
v_lshlrev_b32 v216, 16, v188
v_and_b32 v217, 0xffff0000, v188
v_lshlrev_b32 v218, 16, v189
v_and_b32 v219, 0xffff0000, v189
s_waitcnt lgkmcnt(1)
v_mfma_f32_32x32x16_bf16 v[64:79], a[192:195], a[112:115], v[64:79]
ds_read_b64_tr_b16 a[208:209], v22 offset:4096
ds_read_b64_tr_b16 a[210:211], v22 offset:5120
ds_read_b64_tr_b16 a[212:213], v23 offset:4096
v_lshlrev_b32 v220, 16, v190
v_and_b32 v221, 0xffff0000, v190
v_mfma_f32_32x32x16_bf16 v[80:95], a[196:199], a[112:115], v[80:95]
ds_read_b64_tr_b16 a[214:215], v23 offset:5120
ds_read_b64_tr_b16 a[216:217], v22 offset:6144
ds_read_b64_tr_b16 a[218:219], v22 offset:7168
v_lshlrev_b32 v222, 16, v191
v_and_b32 v223, 0xffff0000, v191
v_mfma_f32_32x32x16_bf16 v[64:79], a[200:203], a[116:119], v[64:79]
ds_read_b64_tr_b16 a[220:221], v23 offset:6144
ds_read_b64_tr_b16 a[222:223], v23 offset:7168
v_mfma_f32_32x32x16_bf16 v[80:95], a[204:207], a[116:119], v[80:95]
s_waitcnt vmcnt(0) lgkmcnt(0)
v_mfma_f32_32x32x16_bf16 v[64:79], a[208:211], a[120:123], v[64:79]
s_barrier
ds_read_b64_tr_b16 a[192:193], v22 offset:8192
ds_read_b64_tr_b16 a[194:195], v22 offset:9216
v_mfma_f32_32x32x16_bf16 v[80:95], a[212:215], a[120:123], v[80:95]
ds_read_b64_tr_b16 a[196:197], v23 offset:8192
ds_read_b64_tr_b16 a[198:199], v23 offset:9216
ds_read_b64_tr_b16 a[200:201], v22 offset:10240
v_mfma_f32_32x32x16_bf16 v[64:79], a[216:219], a[124:127], v[64:79]
s_mov_b32 s43, s34
buffer_store_dwordx4 v[224:227], v12, s[28:31], s43 offen offset:0 sc1
ds_read_b64_tr_b16 a[202:203], v22 offset:11264
ds_read_b64_tr_b16 a[204:205], v23 offset:10240
ds_read_b64_tr_b16 a[206:207], v23 offset:11264
v_mfma_f32_32x32x16_bf16 v[80:95], a[220:223], a[124:127], v[80:95]
buffer_store_dwordx4 v[228:231], v13, s[28:31], s43 offen offset:1024 sc1
s_waitcnt lgkmcnt(0)
v_mfma_f32_32x32x16_bf16 v[64:79], a[192:195], a[128:131], v[64:79]
ds_read_b64_tr_b16 a[208:209], v22 offset:12288
ds_read_b64_tr_b16 a[210:211], v22 offset:13312
ds_read_b64_tr_b16 a[212:213], v23 offset:12288
v_mfma_f32_32x32x16_bf16 v[80:95], a[196:199], a[128:131], v[80:95]
ds_read_b64_tr_b16 a[214:215], v23 offset:13312
ds_read_b64_tr_b16 a[216:217], v22 offset:14336
ds_read_b64_tr_b16 a[218:219], v22 offset:15360
v_mfma_f32_32x32x16_bf16 v[64:79], a[200:203], a[132:135], v[64:79]
buffer_store_dwordx4 v[232:235], v14, s[28:31], s43 offen offset:2048 sc1
ds_read_b64_tr_b16 a[220:221], v23 offset:14336
ds_read_b64_tr_b16 a[222:223], v23 offset:15360
v_mfma_f32_32x32x16_bf16 v[80:95], a[204:207], a[132:135], v[80:95]
buffer_store_dwordx4 v[236:239], v15, s[28:31], s43 offen offset:3072 sc1
s_waitcnt lgkmcnt(0)
v_mfma_f32_32x32x16_bf16 v[64:79], a[208:211], a[136:139], v[64:79]
ds_read_b64_tr_b16 a[192:193], v22 offset:16384
ds_read_b64_tr_b16 a[194:195], v22 offset:17408
ds_read_b64_tr_b16 a[196:197], v23 offset:16384
v_mfma_f32_32x32x16_bf16 v[80:95], a[212:215], a[136:139], v[80:95]
ds_read_b64_tr_b16 a[198:199], v23 offset:17408
ds_read_b64_tr_b16 a[200:201], v22 offset:18432
ds_read_b64_tr_b16 a[202:203], v22 offset:19456
v_mfma_f32_32x32x16_bf16 v[64:79], a[216:219], a[140:143], v[64:79]
ds_read_b64_tr_b16 a[204:205], v23 offset:18432
ds_read_b64_tr_b16 a[206:207], v23 offset:19456
v_mfma_f32_32x32x16_bf16 v[80:95], a[220:223], a[140:143], v[80:95]
s_waitcnt lgkmcnt(0)
v_mfma_f32_32x32x16_bf16 v[64:79], a[192:195], a[144:147], v[64:79]
ds_read_b64_tr_b16 a[208:209], v22 offset:20480
ds_read_b64_tr_b16 a[210:211], v22 offset:21504
ds_read_b64_tr_b16 a[212:213], v23 offset:20480
v_mfma_f32_32x32x16_bf16 v[80:95], a[196:199], a[144:147], v[80:95]
ds_read_b64_tr_b16 a[214:215], v23 offset:21504
ds_read_b64_tr_b16 a[216:217], v22 offset:22528
ds_read_b64_tr_b16 a[218:219], v22 offset:23552
v_mfma_f32_32x32x16_bf16 v[64:79], a[200:203], a[148:151], v[64:79]
ds_read_b64_tr_b16 a[220:221], v23 offset:22528
ds_read_b64_tr_b16 a[222:223], v23 offset:23552
v_mfma_f32_32x32x16_bf16 v[80:95], a[204:207], a[148:151], v[80:95]
s_waitcnt lgkmcnt(0)
v_mfma_f32_32x32x16_bf16 v[64:79], a[208:211], a[152:155], v[64:79]
ds_read_b64_tr_b16 a[192:193], v22 offset:24576
ds_read_b64_tr_b16 a[194:195], v22 offset:25600
ds_read_b64_tr_b16 a[196:197], v23 offset:24576
v_mfma_f32_32x32x16_bf16 v[80:95], a[212:215], a[152:155], v[80:95]
ds_read_b64_tr_b16 a[198:199], v23 offset:25600
ds_read_b64_tr_b16 a[200:201], v22 offset:26624
ds_read_b64_tr_b16 a[202:203], v22 offset:27648
v_mfma_f32_32x32x16_bf16 v[64:79], a[216:219], a[156:159], v[64:79]
ds_read_b64_tr_b16 a[204:205], v23 offset:26624
ds_read_b64_tr_b16 a[206:207], v23 offset:27648
v_mfma_f32_32x32x16_bf16 v[80:95], a[220:223], a[156:159], v[80:95]
s_waitcnt lgkmcnt(0)
v_mfma_f32_32x32x16_bf16 v[64:79], a[192:195], a[160:163], v[64:79]
ds_read_b64_tr_b16 a[208:209], v22 offset:28672
ds_read_b64_tr_b16 a[210:211], v22 offset:29696
ds_read_b64_tr_b16 a[212:213], v23 offset:28672
v_mfma_f32_32x32x16_bf16 v[80:95], a[196:199], a[160:163], v[80:95]
ds_read_b64_tr_b16 a[214:215], v23 offset:29696
ds_read_b64_tr_b16 a[216:217], v22 offset:30720
ds_read_b64_tr_b16 a[218:219], v22 offset:31744
v_mfma_f32_32x32x16_bf16 v[64:79], a[200:203], a[164:167], v[64:79]
ds_read_b64_tr_b16 a[220:221], v23 offset:30720
ds_read_b64_tr_b16 a[222:223], v23 offset:31744
v_mfma_f32_32x32x16_bf16 v[80:95], a[204:207], a[164:167], v[80:95]
s_waitcnt lgkmcnt(0)
v_mfma_f32_32x32x16_bf16 v[64:79], a[208:211], a[168:171], v[64:79]
v_mfma_f32_32x32x16_bf16 v[80:95], a[212:215], a[168:171], v[80:95]
v_mfma_f32_32x32x16_bf16 v[64:79], a[216:219], a[172:175], v[64:79]
v_mfma_f32_32x32x16_bf16 v[80:95], a[220:223], a[172:175], v[80:95]
s_nop 10
v_fma_f32 v64, v128, v64, v192
v_fma_f32 v65, v129, v65, v193
v_cvt_pk_bf16_f32 v176, v64, v65
v_fma_f32 v66, v130, v66, v194
v_fma_f32 v67, v131, v67, v195
v_cvt_pk_bf16_f32 v177, v66, v67
v_fma_f32 v68, v132, v68, v196
v_fma_f32 v69, v133, v69, v197
v_cvt_pk_bf16_f32 v178, v68, v69
v_fma_f32 v70, v134, v70, v198
v_fma_f32 v71, v135, v71, v199
v_cvt_pk_bf16_f32 v179, v70, v71
v_fma_f32 v72, v136, v72, v200
v_fma_f32 v73, v137, v73, v201
v_cvt_pk_bf16_f32 v180, v72, v73
v_fma_f32 v74, v138, v74, v202
v_fma_f32 v75, v139, v75, v203
v_cvt_pk_bf16_f32 v181, v74, v75
v_fma_f32 v76, v140, v76, v204
v_fma_f32 v77, v141, v77, v205
v_cvt_pk_bf16_f32 v182, v76, v77
v_fma_f32 v78, v142, v78, v206
v_fma_f32 v79, v143, v79, v207
v_cvt_pk_bf16_f32 v183, v78, v79
v_fma_f32 v80, v144, v80, v208
v_fma_f32 v81, v145, v81, v209
v_cvt_pk_bf16_f32 v184, v80, v81
v_fma_f32 v82, v146, v82, v210
v_fma_f32 v83, v147, v83, v211
v_cvt_pk_bf16_f32 v185, v82, v83
v_fma_f32 v84, v148, v84, v212
v_fma_f32 v85, v149, v85, v213
v_cvt_pk_bf16_f32 v186, v84, v85
v_fma_f32 v86, v150, v86, v214
v_fma_f32 v87, v151, v87, v215
v_cvt_pk_bf16_f32 v187, v86, v87
v_fma_f32 v88, v152, v88, v216
v_fma_f32 v89, v153, v89, v217
v_cvt_pk_bf16_f32 v188, v88, v89
v_fma_f32 v90, v154, v90, v218
v_fma_f32 v91, v155, v91, v219
v_cvt_pk_bf16_f32 v189, v90, v91
v_fma_f32 v92, v156, v92, v220
v_fma_f32 v93, v157, v93, v221
v_cvt_pk_bf16_f32 v190, v92, v93
v_fma_f32 v94, v158, v94, v222
v_fma_f32 v95, v159, v95, v223
v_cvt_pk_bf16_f32 v191, v94, v95
ds_write_b64 v96, v[176:177]
ds_write_b64 v98, v[178:179]
ds_write_b64 v100, v[180:181]
ds_write_b64 v102, v[182:183]
ds_write_b64 v104, v[184:185]
ds_write_b64 v106, v[186:187]
ds_write_b64 v108, v[188:189]
ds_write_b64 v110, v[190:191]
s_waitcnt lgkmcnt(0)
ds_read_b128 v[240:243], v16 offset:0
ds_read_b128 v[244:247], v16 offset:1024
ds_read_b128 v[248:251], v16 offset:2048
ds_read_b128 v[252:255], v16 offset:3072
s_waitcnt lgkmcnt(3)
s_add_u32 s43, s34, 128
buffer_store_dwordx4 v[240:243], v12, s[28:31], s43 offen offset:0 sc1
s_waitcnt lgkmcnt(2)
buffer_store_dwordx4 v[244:247], v13, s[28:31], s43 offen offset:1024 sc1
s_waitcnt lgkmcnt(1)
buffer_store_dwordx4 v[248:251], v14, s[28:31], s43 offen offset:2048 sc1
s_waitcnt lgkmcnt(0)
buffer_store_dwordx4 v[252:255], v15, s[28:31], s43 offen offset:3072 sc1
s_endpgm
L_mr_ok99x:
s_sleep 1
buffer_load_dwordx2 v[0:1], v30, s[24:27], s45 offen sc1
s_sub_u32 s46, s46, 1
s_waitcnt vmcnt(0)
s_cbranch_scc0 L_mr_sp99
s_branch L_mr_ok99
L_mr_fl0x:
buffer_store_dwordx2 v[6:7], v31, s[24:27], s44 offen sc1
s_branch L_mr_fl0j
L_mr_ok00x:
s_sleep 1
buffer_load_dwordx2 v[0:1], v30, s[24:27], s45 offen sc1
s_sub_u32 s46, s46, 1
s_waitcnt vmcnt(0)
s_cbranch_scc0 L_mr_sp00
s_branch L_mr_ok00
L_mr_fl1x:
buffer_store_dwordx2 v[6:7], v31, s[24:27], s44 offen sc1
s_branch L_mr_fl1j
L_mr_fl5x:
buffer_store_dwordx2 v[6:7], v31, s[24:27], s44 offen sc1
s_branch L_mr_fl5j
L_mr_ok01x:
s_sleep 1
buffer_load_dwordx2 v[0:1], v30, s[24:27], s45 offen sc1
s_sub_u32 s46, s46, 1
s_waitcnt vmcnt(0)
s_cbranch_scc0 L_mr_sp01
s_branch L_mr_ok01
L_mr_ok88x:
s_sleep 1
buffer_load_dwordx2 v[0:1], v30, s[24:27], s45 offen sc1
s_sub_u32 s46, s46, 1
s_waitcnt vmcnt(0)
s_cbranch_scc0 L_mr_sp88
s_branch L_mr_ok88
L_mr_st100x:
buffer_store_dwordx4 v[160:163], v26, s[24:27], s43 offen offset:0 sc1
s_branch L_mr_st100j
L_mr_st101x:
buffer_store_dwordx4 v[164:167], v26, s[24:27], s43 offen offset:1024 sc1
s_branch L_mr_st101j
L_mr_st102x:
buffer_store_dwordx4 v[168:171], v26, s[24:27], s43 offen offset:2048 sc1
s_branch L_mr_st102j
L_mr_st103x:
buffer_store_dwordx4 v[172:175], v26, s[24:27], s43 offen offset:3072 sc1
s_branch L_mr_st103j
L_mr_fl2x:
buffer_store_dwordx2 v[6:7], v31, s[24:27], s44 offen sc1
v_subrev_u32 v2, s35, v26
v_and_b32 v2, 0x1f0, v2
v_lshl_add_u32 v2, v2, 3, s35
s_add_u32 s40, s63, 25165824
buffer_load_dword a224, v2, s[24:27], s40 offen sc1
s_branch L_mr_fl2j
L_mr_ok10x:
s_sleep 1
buffer_load_dwordx2 v[0:1], v30, s[24:27], s45 offen sc1
s_sub_u32 s46, s46, 1
s_waitcnt vmcnt(0)
s_cbranch_scc0 L_mr_sp10
s_branch L_mr_ok10
L_mr_st110x:
buffer_store_dwordx4 v[176:179], v26, s[24:27], s43 offen offset:0 sc1
s_branch L_mr_st110j
L_mr_st111x:
buffer_store_dwordx4 v[180:183], v26, s[24:27], s43 offen offset:1024 sc1
s_branch L_mr_st111j
L_mr_st112x:
buffer_store_dwordx4 v[184:187], v26, s[24:27], s43 offen offset:2048 sc1
s_branch L_mr_st112j
L_mr_st113x:
buffer_store_dwordx4 v[188:191], v26, s[24:27], s43 offen offset:3072 sc1
s_branch L_mr_st113j
L_mr_fl3x:
buffer_store_dwordx2 v[6:7], v31, s[24:27], s44 offen sc1
v_subrev_u32 v2, s35, v26
v_and_b32 v2, 0x1f0, v2
v_lshl_add_u32 v2, v2, 3, s35
s_add_u32 s40, s70, 25165824
buffer_load_dword a224, v2, s[24:27], s40 offen sc1
s_branch L_mr_fl3j
L_mr_ok11x:
s_sleep 1
buffer_load_dwordx2 v[0:1], v30, s[24:27], s45 offen sc1
s_sub_u32 s46, s46, 1
s_waitcnt vmcnt(0)
s_cbranch_scc0 L_mr_sp11
s_branch L_mr_ok11

L_m6:
s_waitcnt vmcnt(9)
v_lshlrev_b32 v194, 16, v192
v_and_b32 v195, 0xffff0000, v192
v_add_f32 v194, s45, v194
v_add_f32 v195, s45, v195
ds_write_b64 v196, v[194:195]
s_add_u32 m0, s41, 16384
s_nop 0
buffer_load_dwordx4 v8, s[16:19], s5 offen lds
s_add_u32 m0, s41, 20480
s_nop 0
buffer_load_dwordx4 v10, s[16:19], s5 offen lds
s_add_u32 m0, s41, 24576
s_nop 0
buffer_load_dwordx4 v8, s[16:19], s6 offen lds
s_add_u32 m0, s41, 28672
s_nop 0
buffer_load_dwordx4 v10, s[16:19], s6 offen lds
v_add_u32 v210, s36, v1
v_subrev_u32 v211, 7, v210
v_min_u32 v210, v210, v211
v_lshlrev_b32 v210, 1, v210
v_add3_u32 v211, v1, s32, -7
v_subrev_u32 v212, 6, v211
v_min_u32 v211, v211, v212
v_lshl_or_b32 v211, v211, 1, 1
v_cmp_gt_u32 vcc, 7, v1
s_nop 1
v_cndmask_b32 v210, v211, v210, vcc
v_mul_u32_u24 v212, 106496, v210
v_lshlrev_b32 v213, 12, v210
v_lshl_add_u32 v26, v1, 4, s35
v_add_u32 v22, 0x10000, v20
v_add_u32 v23, 0x10000, v21
v_add_u32 v24, 0x20000, v20
v_add_u32 v25, 0x20000, v21
v_readlane_b32 s50, v212, 0
v_readlane_b32 s51, v212, 1
v_readlane_b32 s52, v212, 2
v_readlane_b32 s53, v212, 3
v_readlane_b32 s54, v212, 4
v_readlane_b32 s55, v212, 5
v_readlane_b32 s56, v212, 6
v_readlane_b32 s57, v212, 7
v_readlane_b32 s58, v212, 8
v_readlane_b32 s59, v212, 9
v_readlane_b32 s60, v212, 10
v_readlane_b32 s61, v212, 11
v_readlane_b32 s62, v212, 12
v_readlane_b32 s63, v213, 0
v_readlane_b32 s64, v213, 1
v_readlane_b32 s65, v213, 2
v_readlane_b32 s66, v213, 3
v_readlane_b32 s67, v213, 4
v_readlane_b32 s68, v213, 5
v_readlane_b32 s69, v213, 6
v_readlane_b32 s70, v213, 7
v_readlane_b32 s71, v213, 8
v_readlane_b32 s72, v213, 9
v_readlane_b32 s73, v213, 10
v_readlane_b32 s74, v213, 11
v_readlane_b32 s75, v213, 12
s_waitcnt vmcnt(12)
v_readlane_b32 s48, v216, 3
v_readlane_b32 s49, v217, 3
s_nop 3
s_or_b32 s48, s48, 1
s_add_u32 s48, s48, 2
s_add_u32 s49, s49, 1
s_add_u32 s33, s33, s49
s_add_u32 s33, s33, 16
v_mov_b32 v6, s48
v_mov_b32 v7, s33
s_mov_b32 s44, 65536
buffer_store_dwordx2 v[6:7], v31, s[24:27], s44 offen sc1
s_nop 0
v_mov_b32 v7, s49
s_waitcnt lgkmcnt(0)
s_waitcnt vmcnt(11)
s_barrier
ds_read_b128 v[224:227], v29 offset:0
ds_read_b128 v[228:231], v29 offset:32
ds_read_b128 v[232:235], v29 offset:64
ds_read_b128 v[236:239], v29 offset:96
ds_read_b128 v[240:243], v29 offset:128
ds_read_b128 v[244:247], v29 offset:160
ds_read_b128 v[248:251], v29 offset:192
ds_read_b128 v[252:255], v29 offset:224
ds_read_b64_tr_b16 a[192:193], v20 offset:0
ds_read_b64_tr_b16 a[194:195], v20 offset:1024
ds_read_b64_tr_b16 a[196:197], v21 offset:0
ds_read_b64_tr_b16 a[198:199], v21 offset:1024
ds_read_b64_tr_b16 a[200:201], v20 offset:2048
ds_read_b64_tr_b16 a[202:203], v20 offset:3072
ds_read_b64_tr_b16 a[204:205], v21 offset:2048
ds_read_b64_tr_b16 a[206:207], v21 offset:3072
ds_read_b128 v[160:163], v16 offset:0
ds_read_b128 v[164:167], v17 offset:0
ds_read_b128 v[168:171], v18 offset:0
ds_read_b128 v[172:175], v19 offset:0
s_waitcnt lgkmcnt(2)
v_mfma_f32_32x32x16_bf16 v[32:47], a[192:195], v[160:163], v[224:239]
ds_read_b64_tr_b16 a[208:209], v20 offset:4096
ds_read_b64_tr_b16 a[210:211], v20 offset:5120
ds_read_b64_tr_b16 a[212:213], v21 offset:4096
s_add_u32 m0, s47, 8192
v_mfma_f32_32x32x16_bf16 v[48:63], a[196:199], v[160:163], v[240:255]
buffer_load_dwordx4 v12, s[20:23], s82 offen offset:0 lds
ds_read_b64_tr_b16 a[214:215], v21 offset:5120
ds_read_b64_tr_b16 a[216:217], v20 offset:6144
ds_read_b64_tr_b16 a[218:219], v20 offset:7168
v_mfma_f32_32x32x16_bf16 v[32:47], a[200:203], v[164:167], v[32:47]
buffer_load_dwordx4 v13, s[20:23], s82 offen offset:1024 lds
ds_read_b64_tr_b16 a[220:221], v21 offset:6144
ds_read_b64_tr_b16 a[222:223], v21 offset:7168
v_mfma_f32_32x32x16_bf16 v[48:63], a[204:207], v[164:167], v[48:63]
buffer_load_dwordx4 v14, s[20:23], s82 offen offset:2048 lds
s_nop 0
buffer_load_dwordx4 v15, s[20:23], s82 offen offset:3072 lds
s_waitcnt vmcnt(13) lgkmcnt(0)
v_mfma_f32_32x32x16_bf16 v[32:47], a[208:211], v[168:171], v[32:47]
s_barrier
ds_read_b64_tr_b16 a[192:193], v20 offset:8192
ds_read_b64_tr_b16 a[194:195], v20 offset:9216
s_add_u32 m0, s41, 32768
v_mfma_f32_32x32x16_bf16 v[48:63], a[212:215], v[168:171], v[48:63]
buffer_load_dwordx4 v8, s[16:19], s7 offen lds
ds_read_b64_tr_b16 a[196:197], v21 offset:8192
ds_read_b64_tr_b16 a[198:199], v21 offset:9216
ds_read_b64_tr_b16 a[200:201], v20 offset:10240
s_add_u32 m0, s47, 0
v_mfma_f32_32x32x16_bf16 v[32:47], a[216:219], v[172:175], v[32:47]
buffer_load_dwordx4 v12, s[20:23], s83 offen offset:0 lds
ds_read_b64_tr_b16 a[202:203], v20 offset:11264
ds_read_b64_tr_b16 a[204:205], v21 offset:10240
ds_read_b64_tr_b16 a[206:207], v21 offset:11264
v_mfma_f32_32x32x16_bf16 v[48:63], a[220:223], v[172:175], v[48:63]
buffer_load_dwordx4 v13, s[20:23], s83 offen offset:1024 lds
s_nop 0
buffer_load_dwordx4 v14, s[20:23], s83 offen offset:2048 lds
s_waitcnt vmcnt(13)
ds_read_b128 a[0:3], v16 offset:4096
ds_read_b128 a[4:7], v17 offset:4096
ds_read_b128 a[8:11], v18 offset:4096
ds_read_b128 a[12:15], v19 offset:4096
s_waitcnt lgkmcnt(2)
v_mfma_f32_32x32x16_bf16 v[32:47], a[192:195], a[0:3], v[32:47]
ds_read_b64_tr_b16 a[208:209], v20 offset:12288
ds_read_b64_tr_b16 a[210:211], v20 offset:13312
ds_read_b64_tr_b16 a[212:213], v21 offset:12288
v_permlane32_swap_b32 v160, v162
v_mfma_f32_32x32x16_bf16 v[48:63], a[196:199], a[0:3], v[48:63]
buffer_load_dwordx4 v15, s[20:23], s83 offen offset:3072 lds
ds_read_b64_tr_b16 a[214:215], v21 offset:13312
ds_read_b64_tr_b16 a[216:217], v20 offset:14336
ds_read_b64_tr_b16 a[218:219], v20 offset:15360
s_add_u32 m0, s41, 36864
v_mfma_f32_32x32x16_bf16 v[32:47], a[200:203], a[4:7], v[32:47]
buffer_load_dwordx4 v10, s[16:19], s7 offen lds
ds_read_b64_tr_b16 a[220:221], v21 offset:14336
ds_read_b64_tr_b16 a[222:223], v21 offset:15360
s_add_u32 m0, s41, 40960
v_mfma_f32_32x32x16_bf16 v[48:63], a[204:207], a[4:7], v[48:63]
buffer_load_dwordx4 v8, s[16:19], s8 offen lds
s_waitcnt lgkmcnt(8)
s_add_u32 m0, s47, 4096
s_nop 0
buffer_load_dwordx4 v12, s[20:23], s84 offen offset:0 lds
s_waitcnt vmcnt(15) lgkmcnt(0)
v_mfma_f32_32x32x16_bf16 v[32:47], a[208:211], a[8:11], v[32:47]
s_barrier
ds_read_b64_tr_b16 a[192:193], v20 offset:16384
ds_read_b64_tr_b16 a[194:195], v20 offset:17408
v_mfma_f32_32x32x16_bf16 v[48:63], a[212:215], a[8:11], v[48:63]
buffer_load_dwordx4 v13, s[20:23], s84 offen offset:1024 lds
ds_read_b64_tr_b16 a[196:197], v21 offset:16384
ds_read_b64_tr_b16 a[198:199], v21 offset:17408
ds_read_b64_tr_b16 a[200:201], v20 offset:18432
v_mfma_f32_32x32x16_bf16 v[32:47], a[216:219], a[12:15], v[32:47]
buffer_load_dwordx4 v14, s[20:23], s84 offen offset:2048 lds
ds_read_b64_tr_b16 a[202:203], v20 offset:19456
ds_read_b64_tr_b16 a[204:205], v21 offset:18432
ds_read_b64_tr_b16 a[206:207], v21 offset:19456
v_mfma_f32_32x32x16_bf16 v[48:63], a[220:223], a[12:15], v[48:63]
buffer_load_dwordx4 v15, s[20:23], s84 offen offset:3072 lds
s_add_u32 m0, s41, 45056
s_nop 0
buffer_load_dwordx4 v10, s[16:19], s8 offen lds
s_waitcnt vmcnt(12)
ds_read_b128 a[16:19], v16 offset:8192
ds_read_b128 a[20:23], v17 offset:8192
ds_read_b128 a[24:27], v18 offset:8192
ds_read_b128 a[28:31], v19 offset:8192
s_waitcnt lgkmcnt(2)
v_mfma_f32_32x32x16_bf16 v[32:47], a[192:195], a[16:19], v[32:47]
ds_read_b64_tr_b16 a[208:209], v20 offset:20480
ds_read_b64_tr_b16 a[210:211], v20 offset:21504
ds_read_b64_tr_b16 a[212:213], v21 offset:20480
v_permlane32_swap_b32 v161, v163
s_add_u32 m0, s41, 49152
v_mfma_f32_32x32x16_bf16 v[48:63], a[196:199], a[16:19], v[48:63]
buffer_load_dwordx4 v8, s[16:19], s9 offen lds
ds_read_b64_tr_b16 a[214:215], v21 offset:21504
ds_read_b64_tr_b16 a[216:217], v20 offset:22528
ds_read_b64_tr_b16 a[218:219], v20 offset:23552
s_waitcnt lgkmcnt(6)
s_add_u32 m0, s47, 8192
v_mfma_f32_32x32x16_bf16 v[32:47], a[200:203], a[20:23], v[32:47]
buffer_load_dwordx4 v12, s[20:23], s85 offen offset:0 lds
ds_read_b64_tr_b16 a[220:221], v21 offset:22528
ds_read_b64_tr_b16 a[222:223], v21 offset:23552
v_mfma_f32_32x32x16_bf16 v[48:63], a[204:207], a[20:23], v[48:63]
buffer_load_dwordx4 v13, s[20:23], s85 offen offset:1024 lds
s_nop 0
buffer_load_dwordx4 v14, s[20:23], s85 offen offset:2048 lds
s_waitcnt vmcnt(4) lgkmcnt(0)
v_mfma_f32_32x32x16_bf16 v[32:47], a[208:211], a[24:27], v[32:47]
s_barrier
ds_read_b64_tr_b16 a[192:193], v20 offset:24576
ds_read_b64_tr_b16 a[194:195], v20 offset:25600
v_mfma_f32_32x32x16_bf16 v[48:63], a[212:215], a[24:27], v[48:63]
buffer_load_dwordx4 v15, s[20:23], s85 offen offset:3072 lds
ds_read_b64_tr_b16 a[196:197], v21 offset:24576
ds_read_b64_tr_b16 a[198:199], v21 offset:25600
ds_read_b64_tr_b16 a[200:201], v20 offset:26624
s_add_u32 m0, s41, 53248
v_mfma_f32_32x32x16_bf16 v[32:47], a[216:219], a[28:31], v[32:47]
buffer_load_dwordx4 v10, s[16:19], s9 offen lds
ds_read_b64_tr_b16 a[202:203], v20 offset:27648
ds_read_b64_tr_b16 a[204:205], v21 offset:26624
ds_read_b64_tr_b16 a[206:207], v21 offset:27648
s_add_u32 m0, s41, 57344
v_mfma_f32_32x32x16_bf16 v[48:63], a[220:223], a[28:31], v[48:63]
buffer_load_dwordx4 v8, s[16:19], s10 offen lds
v_lshlrev_b32 v96, 16, v160
s_add_u32 m0, s41, 61440
s_nop 0
buffer_load_dwordx4 v10, s[16:19], s10 offen lds
ds_read_b128 a[32:35], v16 offset:0
ds_read_b128 a[36:39], v17 offset:0
ds_read_b128 a[40:43], v18 offset:0
ds_read_b128 a[44:47], v19 offset:0
s_waitcnt lgkmcnt(2)
v_mfma_f32_32x32x16_bf16 v[32:47], a[192:195], a[32:35], v[32:47]
ds_read_b64_tr_b16 a[208:209], v20 offset:28672
ds_read_b64_tr_b16 a[210:211], v20 offset:29696
ds_read_b64_tr_b16 a[212:213], v21 offset:28672
v_and_b32 v97, 0xffff0000, v160
s_waitcnt lgkmcnt(3)
s_add_u32 m0, s47, 0
v_mfma_f32_32x32x16_bf16 v[48:63], a[196:199], a[32:35], v[48:63]
buffer_load_dwordx4 v12, s[20:23], s86 offen offset:0 lds
ds_read_b64_tr_b16 a[214:215], v21 offset:29696
ds_read_b64_tr_b16 a[216:217], v20 offset:30720
ds_read_b64_tr_b16 a[218:219], v20 offset:31744
v_lshlrev_b32 v98, 16, v161
v_mfma_f32_32x32x16_bf16 v[32:47], a[200:203], a[36:39], v[32:47]
buffer_load_dwordx4 v13, s[20:23], s86 offen offset:1024 lds
ds_read_b64_tr_b16 a[220:221], v21 offset:30720
ds_read_b64_tr_b16 a[222:223], v21 offset:31744
v_mfma_f32_32x32x16_bf16 v[48:63], a[204:207], a[36:39], v[48:63]
buffer_load_dwordx4 v14, s[20:23], s86 offen offset:2048 lds
v_and_b32 v99, 0xffff0000, v161
s_nop 0
buffer_load_dwordx4 v15, s[20:23], s86 offen offset:3072 lds
s_waitcnt lgkmcnt(0)
v_mfma_f32_32x32x16_bf16 v[32:47], a[208:211], a[40:43], v[32:47]
ds_read_b64_tr_b16 a[192:193], v20 offset:32768
ds_read_b64_tr_b16 a[194:195], v20 offset:33792
ds_read_b64_tr_b16 a[196:197], v21 offset:32768
ds_read_b128 a[48:51], v16 offset:4096
ds_read_b128 a[52:55], v17 offset:4096
s_add_u32 m0, s41, 65536
v_mfma_f32_32x32x16_bf16 v[48:63], a[212:215], a[40:43], v[48:63]
buffer_load_dwordx4 v8, s[16:19], s11 offen lds
ds_read_b64_tr_b16 a[198:199], v21 offset:33792
ds_read_b64_tr_b16 a[200:201], v20 offset:34816
ds_read_b64_tr_b16 a[202:203], v20 offset:35840
v_lshlrev_b32 v100, 16, v162
s_add_u32 m0, s41, 69632
v_mfma_f32_32x32x16_bf16 v[32:47], a[216:219], a[44:47], v[32:47]
buffer_load_dwordx4 v10, s[16:19], s11 offen lds
ds_read_b64_tr_b16 a[204:205], v21 offset:34816
ds_read_b64_tr_b16 a[206:207], v21 offset:35840
s_add_u32 m0, s41, 73728
v_mfma_f32_32x32x16_bf16 v[48:63], a[220:223], a[44:47], v[48:63]
buffer_load_dwordx4 v8, s[16:19], s12 offen lds
v_and_b32 v101, 0xffff0000, v162
s_add_u32 m0, s41, 77824
s_nop 0
buffer_load_dwordx4 v10, s[16:19], s12 offen lds
ds_read_b128 a[56:59], v18 offset:4096
ds_read_b128 a[60:63], v19 offset:4096
s_waitcnt lgkmcnt(2)
v_mfma_f32_32x32x16_bf16 v[32:47], a[192:195], a[48:51], v[32:47]
ds_read_b64_tr_b16 a[208:209], v20 offset:36864
ds_read_b64_tr_b16 a[210:211], v20 offset:37888
ds_read_b64_tr_b16 a[212:213], v21 offset:36864
v_lshlrev_b32 v102, 16, v163
s_waitcnt lgkmcnt(3)
s_add_u32 m0, s47, 4096
v_mfma_f32_32x32x16_bf16 v[48:63], a[196:199], a[48:51], v[48:63]
buffer_load_dwordx4 v12, s[20:23], s87 offen offset:0 lds
ds_read_b64_tr_b16 a[214:215], v21 offset:37888
ds_read_b64_tr_b16 a[216:217], v20 offset:38912
ds_read_b64_tr_b16 a[218:219], v20 offset:39936
v_and_b32 v103, 0xffff0000, v163
v_mfma_f32_32x32x16_bf16 v[32:47], a[200:203], a[52:55], v[32:47]
buffer_load_dwordx4 v13, s[20:23], s87 offen offset:1024 lds
ds_read_b64_tr_b16 a[220:221], v21 offset:38912
ds_read_b64_tr_b16 a[222:223], v21 offset:39936
v_mfma_f32_32x32x16_bf16 v[48:63], a[204:207], a[52:55], v[48:63]
buffer_load_dwordx4 v14, s[20:23], s87 offen offset:2048 lds
v_permlane32_swap_b32 v164, v166
s_nop 0
buffer_load_dwordx4 v15, s[20:23], s87 offen offset:3072 lds
s_waitcnt lgkmcnt(0)
v_mfma_f32_32x32x16_bf16 v[32:47], a[208:211], a[56:59], v[32:47]
ds_read_b64_tr_b16 a[192:193], v20 offset:40960
ds_read_b64_tr_b16 a[194:195], v20 offset:41984
ds_read_b64_tr_b16 a[196:197], v21 offset:40960
s_waitcnt vmcnt(15)
ds_read_b128 a[64:67], v16 offset:8192
s_add_u32 m0, s41, 81920
v_mfma_f32_32x32x16_bf16 v[48:63], a[212:215], a[56:59], v[48:63]
buffer_load_dwordx4 v8, s[16:19], s13 offen lds
ds_read_b64_tr_b16 a[198:199], v21 offset:41984
ds_read_b64_tr_b16 a[200:201], v20 offset:43008
ds_read_b64_tr_b16 a[202:203], v20 offset:44032
v_permlane32_swap_b32 v165, v167
s_add_u32 m0, s41, 86016
v_mfma_f32_32x32x16_bf16 v[32:47], a[216:219], a[60:63], v[32:47]
buffer_load_dwordx4 v10, s[16:19], s13 offen lds
ds_read_b64_tr_b16 a[204:205], v21 offset:43008
ds_read_b64_tr_b16 a[206:207], v21 offset:44032
s_add_u32 m0, s41, 90112
v_mfma_f32_32x32x16_bf16 v[48:63], a[220:223], a[60:63], v[48:63]
buffer_load_dwordx4 v8, s[16:19], s14 offen lds
ds_read_b128 a[68:71], v17 offset:8192
s_add_u32 m0, s41, 94208
s_nop 0
buffer_load_dwordx4 v10, s[16:19], s14 offen lds
ds_read_b128 a[72:75], v18 offset:8192
ds_read_b128 a[76:79], v19 offset:8192
s_waitcnt lgkmcnt(2)
v_mfma_f32_32x32x16_bf16 v[32:47], a[192:195], a[64:67], v[32:47]
ds_read_b64_tr_b16 a[208:209], v20 offset:45056
ds_read_b64_tr_b16 a[210:211], v20 offset:46080
ds_read_b64_tr_b16 a[212:213], v21 offset:45056
v_lshlrev_b32 v104, 16, v164
s_waitcnt vmcnt(12)
ds_read_b128 a[80:83], v16 offset:0
v_mfma_f32_32x32x16_bf16 v[48:63], a[196:199], a[64:67], v[48:63]
s_mov_b32 s45, 65536
buffer_load_dwordx2 v[0:1], v30, s[24:27], s45 offen sc1
ds_read_b64_tr_b16 a[214:215], v21 offset:46080
ds_read_b64_tr_b16 a[216:217], v20 offset:47104
ds_read_b64_tr_b16 a[218:219], v20 offset:48128
s_waitcnt lgkmcnt(7)
s_add_u32 m0, s47, 8192
v_mfma_f32_32x32x16_bf16 v[32:47], a[200:203], a[68:71], v[32:47]
buffer_load_dwordx4 v12, s[20:23], s88 offen offset:0 lds
ds_read_b64_tr_b16 a[220:221], v21 offset:47104
ds_read_b64_tr_b16 a[222:223], v21 offset:48128
v_and_b32 v105, 0xffff0000, v164
v_mfma_f32_32x32x16_bf16 v[48:63], a[204:207], a[68:71], v[48:63]
buffer_load_dwordx4 v13, s[20:23], s88 offen offset:1024 lds
ds_read_b128 a[84:87], v17 offset:0
s_nop 0
buffer_load_dwordx4 v14, s[20:23], s88 offen offset:2048 lds
s_waitcnt vmcnt(14) lgkmcnt(1)
v_mfma_f32_32x32x16_bf16 v[32:47], a[208:211], a[72:75], v[32:47]
s_barrier
ds_read_b64_tr_b16 a[192:193], v20 offset:49152
ds_read_b64_tr_b16 a[194:195], v20 offset:50176
v_lshlrev_b32 v106, 16, v165
v_mfma_f32_32x32x16_bf16 v[48:63], a[212:215], a[72:75], v[48:63]
buffer_load_dwordx4 v15, s[20:23], s88 offen offset:3072 lds
ds_read_b64_tr_b16 a[196:197], v21 offset:49152
ds_read_b64_tr_b16 a[198:199], v21 offset:50176
ds_read_b64_tr_b16 a[200:201], v20 offset:51200
s_add_u32 m0, s41, 98304
v_mfma_f32_32x32x16_bf16 v[32:47], a[216:219], a[76:79], v[32:47]
buffer_load_dwordx4 v8, s[16:19], s15 offen lds
ds_read_b64_tr_b16 a[202:203], v20 offset:52224
ds_read_b64_tr_b16 a[204:205], v21 offset:51200
ds_read_b64_tr_b16 a[206:207], v21 offset:52224
v_and_b32 v107, 0xffff0000, v165
s_add_u32 m0, s41, 102400
v_mfma_f32_32x32x16_bf16 v[48:63], a[220:223], a[76:79], v[48:63]
buffer_load_dwordx4 v10, s[16:19], s15 offen lds
ds_read_b128 a[88:91], v18 offset:0
s_add_u32 s16, s16, 1384448
s_addc_u32 s17, s17, 0
s_sub_u32 s18, s18, 1384448
v_add_u32 v8, v223, v8
v_add_u32 v9, v223, v9
v_add_u32 v10, v223, v10
v_add_u32 v11, v223, v11
s_add_u32 m0, s41, 106496
s_nop 0
buffer_load_dwordx4 v8, s[16:19], s50 offen lds
ds_read_b128 a[92:95], v19 offset:0
s_waitcnt lgkmcnt(2)
v_mfma_f32_32x32x16_bf16 v[32:47], a[192:195], a[80:83], v[32:47]
ds_read_b64_tr_b16 a[208:209], v20 offset:53248
ds_read_b64_tr_b16 a[210:211], v20 offset:54272
ds_read_b64_tr_b16 a[212:213], v21 offset:53248
v_lshlrev_b32 v108, 16, v166
s_waitcnt vmcnt(12)
ds_read_b128 a[96:99], v16 offset:4096
s_waitcnt lgkmcnt(4)
s_add_u32 m0, s47, 0
v_mfma_f32_32x32x16_bf16 v[48:63], a[196:199], a[80:83], v[48:63]
buffer_load_dwordx4 v12, s[20:23], s89 offen offset:0 lds
ds_read_b64_tr_b16 a[214:215], v21 offset:54272
ds_read_b64_tr_b16 a[216:217], v20 offset:55296
ds_read_b64_tr_b16 a[218:219], v20 offset:56320
v_mfma_f32_32x32x16_bf16 v[32:47], a[200:203], a[84:87], v[32:47]
buffer_load_dwordx4 v13, s[20:23], s89 offen offset:1024 lds
ds_read_b64_tr_b16 a[220:221], v21 offset:55296
ds_read_b64_tr_b16 a[222:223], v21 offset:56320
v_and_b32 v109, 0xffff0000, v166
v_mfma_f32_32x32x16_bf16 v[48:63], a[204:207], a[84:87], v[48:63]
buffer_load_dwordx4 v14, s[20:23], s89 offen offset:2048 lds
ds_read_b128 a[100:103], v17 offset:4096
s_nop 0
buffer_load_dwordx4 v15, s[20:23], s89 offen offset:3072 lds
s_waitcnt lgkmcnt(1)
v_mfma_f32_32x32x16_bf16 v[32:47], a[208:211], a[88:91], v[32:47]
ds_read_b64_tr_b16 a[192:193], v20 offset:57344
ds_read_b64_tr_b16 a[194:195], v20 offset:58368
ds_read_b64_tr_b16 a[196:197], v21 offset:57344
ds_read_b128 a[104:107], v18 offset:4096
ds_read_b128 a[108:111], v19 offset:4096
s_add_u32 m0, s41, 0
v_mfma_f32_32x32x16_bf16 v[48:63], a[212:215], a[88:91], v[48:63]
buffer_load_dwordx4 v10, s[16:19], s50 offen lds
ds_read_b64_tr_b16 a[198:199], v21 offset:58368
ds_read_b64_tr_b16 a[200:201], v20 offset:59392
ds_read_b64_tr_b16 a[202:203], v20 offset:60416
v_lshlrev_b32 v110, 16, v167
s_waitcnt lgkmcnt(3)
s_add_u32 m0, s47, 4096
v_mfma_f32_32x32x16_bf16 v[32:47], a[216:219], a[92:95], v[32:47]
buffer_load_dwordx4 v12, s[20:23], s90 offen offset:0 lds
ds_read_b64_tr_b16 a[204:205], v21 offset:59392
ds_read_b64_tr_b16 a[206:207], v21 offset:60416
v_mfma_f32_32x32x16_bf16 v[48:63], a[220:223], a[92:95], v[48:63]
buffer_load_dwordx4 v13, s[20:23], s90 offen offset:1024 lds
v_and_b32 v111, 0xffff0000, v167
s_nop 0
buffer_load_dwordx4 v14, s[20:23], s90 offen offset:2048 lds
s_waitcnt lgkmcnt(0)
v_mfma_f32_32x32x16_bf16 v[32:47], a[192:195], a[96:99], v[32:47]
ds_read_b64_tr_b16 a[208:209], v20 offset:61440
ds_read_b64_tr_b16 a[210:211], v20 offset:62464
ds_read_b64_tr_b16 a[212:213], v21 offset:61440
s_waitcnt vmcnt(15)
L_m6_sp99:
v_subrev_u32 v2, s49, v1
v_lshrrev_b32 v2, 4, v2
v_xor_b32 v3, s48, v0
v_xor_b32 v2, 1, v2
v_or_b32 v2, v2, v3
v_cmp_eq_u32 vcc, 0, v2
s_nop 1
s_and_b32 s44, vcc_lo, 127
s_cmp_eq_u32 s44, 127
s_cbranch_scc0 L_m6_ok99x
L_m6_ok99:
v_cmp_eq_u32 vcc, s33, v1
s_nop 1
s_and_b32 s44, s44, vcc_lo
s_cmp_eq_u32 s44, 0x7f
s_cselect_b32 s32, 1, 0
s_cselect_b32 s93, 0, 8388608
v_mfma_f32_32x32x16_bf16 v[48:63], a[196:199], a[96:99], v[48:63]
buffer_load_dwordx4 v15, s[20:23], s90 offen offset:3072 lds
ds_read_b64_tr_b16 a[214:215], v21 offset:62464
ds_read_b64_tr_b16 a[216:217], v20 offset:63488
ds_read_b64_tr_b16 a[218:219], v20 offset:64512
v_permlane32_swap_b32 v168, v170
s_add_u32 m0, s41, 4096
v_mfma_f32_32x32x16_bf16 v[32:47], a[200:203], a[100:103], v[32:47]
buffer_load_dwordx4 v8, s[16:19], s51 offen lds
ds_read_b64_tr_b16 a[220:221], v21 offset:63488
ds_read_b64_tr_b16 a[222:223], v21 offset:64512
s_add_u32 m0, s41, 8192
v_mfma_f32_32x32x16_bf16 v[48:63], a[204:207], a[100:103], v[48:63]
buffer_load_dwordx4 v10, s[16:19], s51 offen lds
v_permlane32_swap_b32 v169, v171
s_add_u32 m0, s41, 12288
s_nop 0
buffer_load_dwordx4 v8, s[16:19], s52 offen lds
s_waitcnt lgkmcnt(0)
v_mfma_f32_32x32x16_bf16 v[32:47], a[208:211], a[104:107], v[32:47]
ds_read_b64_tr_b16 a[192:193], v22 offset:0
ds_read_b64_tr_b16 a[194:195], v22 offset:1024
ds_read_b64_tr_b16 a[196:197], v23 offset:0
s_waitcnt vmcnt(15)
ds_read_b128 a[112:115], v16 offset:8192
s_add_u32 m0, s41, 16384
v_mfma_f32_32x32x16_bf16 v[48:63], a[212:215], a[104:107], v[48:63]
buffer_load_dwordx4 v10, s[16:19], s52 offen lds
ds_read_b64_tr_b16 a[198:199], v23 offset:1024
ds_read_b64_tr_b16 a[200:201], v22 offset:2048
ds_read_b64_tr_b16 a[202:203], v22 offset:3072
v_lshlrev_b32 v112, 16, v168
s_add_u32 m0, s41, 20480
v_mfma_f32_32x32x16_bf16 v[32:47], a[216:219], a[108:111], v[32:47]
buffer_load_dwordx4 v8, s[16:19], s53 offen lds
ds_read_b64_tr_b16 a[204:205], v23 offset:2048
ds_read_b64_tr_b16 a[206:207], v23 offset:3072
s_add_u32 m0, s41, 24576
v_mfma_f32_32x32x16_bf16 v[48:63], a[220:223], a[108:111], v[48:63]
buffer_load_dwordx4 v10, s[16:19], s53 offen lds
ds_read_b128 a[116:119], v17 offset:8192
s_add_u32 m0, s41, 28672
s_nop 0
buffer_load_dwordx4 v8, s[16:19], s54 offen lds
ds_read_b128 a[120:123], v18 offset:8192
ds_read_b128 a[124:127], v19 offset:8192
s_waitcnt lgkmcnt(2)
v_mfma_f32_32x32x16_bf16 v[32:47], a[192:195], a[112:115], v[32:47]
ds_read_b64_tr_b16 a[208:209], v22 offset:4096
ds_read_b64_tr_b16 a[210:211], v22 offset:5120
ds_read_b64_tr_b16 a[212:213], v23 offset:4096
v_and_b32 v113, 0xffff0000, v168
s_waitcnt vmcnt(12)
ds_read_b128 a[128:131], v16 offset:0
s_waitcnt lgkmcnt(4)
s_add_u32 m0, s47, 8192
v_mfma_f32_32x32x16_bf16 v[48:63], a[196:199], a[112:115], v[48:63]
buffer_load_dwordx4 v12, s[20:23], s91 offen offset:0 lds
ds_read_b64_tr_b16 a[214:215], v23 offset:5120
ds_read_b64_tr_b16 a[216:217], v22 offset:6144
ds_read_b64_tr_b16 a[218:219], v22 offset:7168
v_mfma_f32_32x32x16_bf16 v[32:47], a[200:203], a[116:119], v[32:47]
buffer_load_dwordx4 v13, s[20:23], s91 offen offset:1024 lds
ds_read_b64_tr_b16 a[220:221], v23 offset:6144
ds_read_b64_tr_b16 a[222:223], v23 offset:7168
v_lshlrev_b32 v114, 16, v169
v_mfma_f32_32x32x16_bf16 v[48:63], a[204:207], a[116:119], v[48:63]
buffer_load_dwordx4 v14, s[20:23], s91 offen offset:2048 lds
ds_read_b128 a[132:135], v17 offset:0
s_nop 0
buffer_load_dwordx4 v15, s[20:23], s91 offen offset:3072 lds
s_waitcnt lgkmcnt(1)
v_mfma_f32_32x32x16_bf16 v[32:47], a[208:211], a[120:123], v[32:47]
s_barrier
ds_read_b64_tr_b16 a[192:193], v22 offset:8192
ds_read_b64_tr_b16 a[194:195], v22 offset:9216
v_and_b32 v115, 0xffff0000, v169
s_add_u32 m0, s41, 32768
v_mfma_f32_32x32x16_bf16 v[48:63], a[212:215], a[120:123], v[48:63]
buffer_load_dwordx4 v10, s[16:19], s54 offen lds
ds_read_b64_tr_b16 a[196:197], v23 offset:8192
ds_read_b64_tr_b16 a[198:199], v23 offset:9216
ds_read_b64_tr_b16 a[200:201], v22 offset:10240
s_add_u32 m0, s41, 36864
v_mfma_f32_32x32x16_bf16 v[32:47], a[216:219], a[124:127], v[32:47]
buffer_load_dwordx4 v8, s[16:19], s55 offen lds
ds_read_b64_tr_b16 a[202:203], v22 offset:11264
ds_read_b64_tr_b16 a[204:205], v23 offset:10240
ds_read_b64_tr_b16 a[206:207], v23 offset:11264
v_lshlrev_b32 v116, 16, v170
s_add_u32 m0, s41, 40960
v_mfma_f32_32x32x16_bf16 v[48:63], a[220:223], a[124:127], v[48:63]
buffer_load_dwordx4 v10, s[16:19], s55 offen lds
ds_read_b128 a[136:139], v18 offset:0
s_add_u32 m0, s41, 45056
s_nop 0
buffer_load_dwordx4 v8, s[16:19], s56 offen lds
ds_read_b128 a[140:143], v19 offset:0
s_waitcnt lgkmcnt(2)
v_mfma_f32_32x32x16_bf16 v[32:47], a[192:195], a[128:131], v[32:47]
ds_read_b64_tr_b16 a[208:209], v22 offset:12288
ds_read_b64_tr_b16 a[210:211], v22 offset:13312
ds_read_b64_tr_b16 a[212:213], v23 offset:12288
v_and_b32 v117, 0xffff0000, v170
s_waitcnt vmcnt(15)
ds_read_b128 a[144:147], v16 offset:4096
s_waitcnt lgkmcnt(4)
s_add_u32 m0, s47, 0
v_mfma_f32_32x32x16_bf16 v[48:63], a[196:199], a[128:131], v[48:63]
buffer_load_dwordx4 v12, s[20:23], s92 offen offset:0 lds
ds_read_b64_tr_b16 a[214:215], v23 offset:13312
ds_read_b64_tr_b16 a[216:217], v22 offset:14336
ds_read_b64_tr_b16 a[218:219], v22 offset:15360
v_mfma_f32_32x32x16_bf16 v[32:47], a[200:203], a[132:135], v[32:47]
buffer_load_dwordx4 v13, s[20:23], s92 offen offset:1024 lds
ds_read_b64_tr_b16 a[220:221], v23 offset:14336
ds_read_b64_tr_b16 a[222:223], v23 offset:15360
v_lshlrev_b32 v118, 16, v171
v_mfma_f32_32x32x16_bf16 v[48:63], a[204:207], a[132:135], v[48:63]
buffer_load_dwordx4 v14, s[20:23], s92 offen offset:2048 lds
ds_read_b128 a[148:151], v17 offset:4096
s_nop 0
buffer_load_dwordx4 v15, s[20:23], s92 offen offset:3072 lds
s_waitcnt lgkmcnt(1)
v_mfma_f32_32x32x16_bf16 v[32:47], a[208:211], a[136:139], v[32:47]
ds_read_b64_tr_b16 a[192:193], v22 offset:16384
ds_read_b64_tr_b16 a[194:195], v22 offset:17408
ds_read_b64_tr_b16 a[196:197], v23 offset:16384
ds_read_b128 a[152:155], v18 offset:4096
ds_read_b128 a[156:159], v19 offset:4096
s_add_u32 m0, s41, 49152
v_mfma_f32_32x32x16_bf16 v[48:63], a[212:215], a[136:139], v[48:63]
buffer_load_dwordx4 v10, s[16:19], s56 offen lds
ds_read_b64_tr_b16 a[198:199], v23 offset:17408
ds_read_b64_tr_b16 a[200:201], v22 offset:18432
ds_read_b64_tr_b16 a[202:203], v22 offset:19456
v_and_b32 v119, 0xffff0000, v171
s_add_u32 m0, s41, 53248
v_mfma_f32_32x32x16_bf16 v[32:47], a[216:219], a[140:143], v[32:47]
buffer_load_dwordx4 v8, s[16:19], s57 offen lds
ds_read_b64_tr_b16 a[204:205], v23 offset:18432
ds_read_b64_tr_b16 a[206:207], v23 offset:19456
s_add_u32 m0, s41, 57344
v_mfma_f32_32x32x16_bf16 v[48:63], a[220:223], a[140:143], v[48:63]
buffer_load_dwordx4 v10, s[16:19], s57 offen lds
v_permlane32_swap_b32 v172, v174
s_add_u32 m0, s41, 61440
s_nop 0
buffer_load_dwordx4 v8, s[16:19], s58 offen lds
s_waitcnt lgkmcnt(0)
v_mfma_f32_32x32x16_bf16 v[32:47], a[192:195], a[144:147], v[32:47]
ds_read_b64_tr_b16 a[208:209], v22 offset:20480
ds_read_b64_tr_b16 a[210:211], v22 offset:21504
ds_read_b64_tr_b16 a[212:213], v23 offset:20480
s_waitcnt vmcnt(12)
ds_read_b128 a[160:163], v16 offset:8192
s_add_u32 m0, s41, 65536
v_mfma_f32_32x32x16_bf16 v[48:63], a[196:199], a[144:147], v[48:63]
buffer_load_dwordx4 v10, s[16:19], s58 offen lds
ds_read_b64_tr_b16 a[214:215], v23 offset:21504
ds_read_b64_tr_b16 a[216:217], v22 offset:22528
ds_read_b64_tr_b16 a[218:219], v22 offset:23552
v_permlane32_swap_b32 v173, v175
v_mfma_f32_32x32x16_bf16 v[32:47], a[200:203], a[148:151], v[32:47]
ds_read_b64_tr_b16 a[220:221], v23 offset:22528
ds_read_b64_tr_b16 a[222:223], v23 offset:23552
ds_read_b128 a[164:167], v17 offset:8192
ds_read_b128 a[168:171], v18 offset:8192
ds_read_b128 a[172:175], v19 offset:8192
v_mfma_f32_32x32x16_bf16 v[48:63], a[204:207], a[148:151], v[48:63]
v_lshlrev_b32 v120, 16, v172
ds_read_b128 v[224:227], v29 offset:512
ds_read_b128 v[228:231], v29 offset:544
ds_read_b128 v[232:235], v29 offset:576
s_waitcnt lgkmcnt(6)
v_mfma_f32_32x32x16_bf16 v[32:47], a[208:211], a[152:155], v[32:47]
ds_read_b64_tr_b16 a[192:193], v22 offset:24576
ds_read_b64_tr_b16 a[194:195], v22 offset:25600
ds_read_b64_tr_b16 a[196:197], v23 offset:24576
ds_read_b128 v[236:239], v29 offset:608
ds_read_b128 v[240:243], v29 offset:640
v_mfma_f32_32x32x16_bf16 v[48:63], a[212:215], a[152:155], v[48:63]
ds_read_b64_tr_b16 a[198:199], v23 offset:25600
ds_read_b64_tr_b16 a[200:201], v22 offset:26624
ds_read_b64_tr_b16 a[202:203], v22 offset:27648
v_and_b32 v121, 0xffff0000, v172
ds_read_b128 v[244:247], v29 offset:672
ds_read_b128 v[248:251], v29 offset:704
v_mfma_f32_32x32x16_bf16 v[32:47], a[216:219], a[156:159], v[32:47]
ds_read_b64_tr_b16 a[204:205], v23 offset:26624
ds_read_b64_tr_b16 a[206:207], v23 offset:27648
ds_read_b128 v[252:255], v29 offset:736
v_lshlrev_b32 v122, 16, v173
v_and_b32 v123, 0xffff0000, v173
v_mfma_f32_32x32x16_bf16 v[48:63], a[220:223], a[156:159], v[48:63]
v_lshlrev_b32 v124, 16, v174
v_and_b32 v125, 0xffff0000, v174
v_lshlrev_b32 v126, 16, v175
v_and_b32 v127, 0xffff0000, v175
s_waitcnt lgkmcnt(1)
v_mfma_f32_32x32x16_bf16 v[32:47], a[192:195], a[160:163], v[32:47]
ds_read_b64_tr_b16 a[208:209], v22 offset:28672
ds_read_b64_tr_b16 a[210:211], v22 offset:29696
ds_read_b64_tr_b16 a[212:213], v23 offset:28672
s_waitcnt vmcnt(5)
ds_read_b128 a[176:179], v16 offset:0
ds_read_b128 a[180:183], v17 offset:0
v_mfma_f32_32x32x16_bf16 v[48:63], a[196:199], a[160:163], v[48:63]
ds_read_b64_tr_b16 a[214:215], v23 offset:29696
ds_read_b64_tr_b16 a[216:217], v22 offset:30720
ds_read_b64_tr_b16 a[218:219], v22 offset:31744
ds_read_b128 a[184:187], v18 offset:0
ds_read_b128 a[188:191], v19 offset:0
v_mfma_f32_32x32x16_bf16 v[32:47], a[200:203], a[164:167], v[32:47]
ds_read_b64_tr_b16 a[220:221], v23 offset:30720
ds_read_b64_tr_b16 a[222:223], v23 offset:31744
v_mfma_f32_32x32x16_bf16 v[48:63], a[204:207], a[164:167], v[48:63]
s_waitcnt lgkmcnt(0)
s_waitcnt lgkmcnt(0)
v_mfma_f32_32x32x16_bf16 v[32:47], a[208:211], a[168:171], v[32:47]
s_barrier
ds_read_b64_tr_b16 a[192:193], v22 offset:32768
ds_read_b64_tr_b16 a[194:195], v22 offset:33792
s_add_u32 m0, s41, 69632
v_mfma_f32_32x32x16_bf16 v[48:63], a[212:215], a[168:171], v[48:63]
buffer_load_dwordx4 v8, s[16:19], s59 offen lds
ds_read_b64_tr_b16 a[196:197], v23 offset:32768
ds_read_b64_tr_b16 a[198:199], v23 offset:33792
ds_read_b64_tr_b16 a[200:201], v22 offset:34816
s_add_u32 m0, s41, 73728
v_mfma_f32_32x32x16_bf16 v[32:47], a[216:219], a[172:175], v[32:47]
buffer_load_dwordx4 v10, s[16:19], s59 offen lds
ds_read_b64_tr_b16 a[202:203], v22 offset:35840
ds_read_b64_tr_b16 a[204:205], v23 offset:34816
ds_read_b64_tr_b16 a[206:207], v23 offset:35840
s_add_u32 m0, s41, 77824
v_mfma_f32_32x32x16_bf16 v[48:63], a[220:223], a[172:175], v[48:63]
buffer_load_dwordx4 v8, s[16:19], s60 offen lds
s_add_u32 m0, s41, 81920
s_nop 0
buffer_load_dwordx4 v10, s[16:19], s60 offen lds
s_waitcnt lgkmcnt(0)
v_mfma_f32_32x32x16_bf16 v[32:47], a[192:195], a[176:179], v[32:47]
ds_read_b64_tr_b16 a[208:209], v22 offset:36864
ds_read_b64_tr_b16 a[210:211], v22 offset:37888
ds_read_b64_tr_b16 a[212:213], v23 offset:36864
s_add_u32 m0, s41, 86016
v_mfma_f32_32x32x16_bf16 v[48:63], a[196:199], a[176:179], v[48:63]
buffer_load_dwordx4 v8, s[16:19], s61 offen lds
ds_read_b64_tr_b16 a[214:215], v23 offset:37888
ds_read_b64_tr_b16 a[216:217], v22 offset:38912
ds_read_b64_tr_b16 a[218:219], v22 offset:39936
s_add_u32 m0, s41, 90112
v_mfma_f32_32x32x16_bf16 v[32:47], a[200:203], a[180:183], v[32:47]
buffer_load_dwordx4 v10, s[16:19], s61 offen lds
ds_read_b64_tr_b16 a[220:221], v23 offset:38912
ds_read_b64_tr_b16 a[222:223], v23 offset:39936
v_mfma_f32_32x32x16_bf16 v[48:63], a[204:207], a[180:183], v[48:63]
s_waitcnt lgkmcnt(0)
v_mfma_f32_32x32x16_bf16 v[32:47], a[208:211], a[184:187], v[32:47]
ds_read_b64_tr_b16 a[192:193], v22 offset:40960
ds_read_b64_tr_b16 a[194:195], v22 offset:41984
ds_read_b64_tr_b16 a[196:197], v23 offset:40960
v_mfma_f32_32x32x16_bf16 v[48:63], a[212:215], a[184:187], v[48:63]
ds_read_b64_tr_b16 a[198:199], v23 offset:41984
ds_read_b64_tr_b16 a[200:201], v22 offset:43008
ds_read_b64_tr_b16 a[202:203], v22 offset:44032
v_mfma_f32_32x32x16_bf16 v[32:47], a[216:219], a[188:191], v[32:47]
ds_read_b64_tr_b16 a[204:205], v23 offset:43008
ds_read_b64_tr_b16 a[206:207], v23 offset:44032
v_mfma_f32_32x32x16_bf16 v[48:63], a[220:223], a[188:191], v[48:63]
s_nop 8
v_mul_f32 v32, v96, v32
v_mul_f32 v33, v97, v33
v_cvt_pk_bf16_f32 v160, v32, v33
v_mul_f32 v34, v98, v34
v_mul_f32 v35, v99, v35
v_cvt_pk_bf16_f32 v161, v34, v35
v_mul_f32 v36, v100, v36
v_mul_f32 v37, v101, v37
v_cvt_pk_bf16_f32 v162, v36, v37
v_mul_f32 v38, v102, v38
v_mul_f32 v39, v103, v39
v_cvt_pk_bf16_f32 v163, v38, v39
v_mul_f32 v40, v104, v40
v_mul_f32 v41, v105, v41
v_cvt_pk_bf16_f32 v164, v40, v41
v_mul_f32 v42, v106, v42
v_mul_f32 v43, v107, v43
v_cvt_pk_bf16_f32 v165, v42, v43
v_mul_f32 v44, v108, v44
v_mul_f32 v45, v109, v45
v_cvt_pk_bf16_f32 v166, v44, v45
v_mul_f32 v46, v110, v46
v_mul_f32 v47, v111, v47
v_cvt_pk_bf16_f32 v167, v46, v47
v_mul_f32 v48, v112, v48
v_mul_f32 v49, v113, v49
v_cvt_pk_bf16_f32 v168, v48, v49
v_mul_f32 v50, v114, v50
v_mul_f32 v51, v115, v51
v_cvt_pk_bf16_f32 v169, v50, v51
v_mul_f32 v52, v116, v52
v_mul_f32 v53, v117, v53
v_cvt_pk_bf16_f32 v170, v52, v53
v_mul_f32 v54, v118, v54
v_mul_f32 v55, v119, v55
v_cvt_pk_bf16_f32 v171, v54, v55
v_mul_f32 v56, v120, v56
v_mul_f32 v57, v121, v57
v_cvt_pk_bf16_f32 v172, v56, v57
v_mul_f32 v58, v122, v58
v_mul_f32 v59, v123, v59
v_cvt_pk_bf16_f32 v173, v58, v59
v_mul_f32 v60, v124, v60
v_mul_f32 v61, v125, v61
v_cvt_pk_bf16_f32 v174, v60, v61
v_mul_f32 v62, v126, v62
v_mul_f32 v63, v127, v63
v_cvt_pk_bf16_f32 v175, v62, v63
s_waitcnt lgkmcnt(0)
v_mfma_f32_32x32x16_bf16 v[32:47], a[192:195], v[160:163], v[224:239]
ds_read_b64_tr_b16 a[208:209], v20 offset:0
ds_read_b64_tr_b16 a[210:211], v20 offset:1024
ds_read_b64_tr_b16 a[212:213], v21 offset:0
v_lshlrev_b32 v192, 16, v160
v_and_b32 v193, 0xffff0000, v160
v_mfma_f32_32x32x16_bf16 v[48:63], a[196:199], v[160:163], v[240:255]
ds_read_b64_tr_b16 a[214:215], v21 offset:1024
ds_read_b64_tr_b16 a[216:217], v20 offset:2048
ds_read_b64_tr_b16 a[218:219], v20 offset:3072
v_lshlrev_b32 v194, 16, v161
v_and_b32 v195, 0xffff0000, v161
v_mfma_f32_32x32x16_bf16 v[32:47], a[200:203], v[164:167], v[32:47]
s_add_u32 s43, s63, 16777216
buffer_store_dwordx4 v[160:163], v26, s[24:27], s43 offen offset:0 sc1
ds_read_b64_tr_b16 a[220:221], v21 offset:2048
ds_read_b64_tr_b16 a[222:223], v21 offset:3072
v_mfma_f32_32x32x16_bf16 v[48:63], a[204:207], v[164:167], v[48:63]
buffer_store_dwordx4 v[164:167], v26, s[24:27], s43 offen offset:1024 sc1
s_waitcnt lgkmcnt(0)
v_mfma_f32_32x32x16_bf16 v[32:47], a[208:211], v[168:171], v[32:47]
ds_read_b64_tr_b16 a[192:193], v20 offset:4096
ds_read_b64_tr_b16 a[194:195], v20 offset:5120
ds_read_b64_tr_b16 a[196:197], v21 offset:4096
v_lshlrev_b32 v196, 16, v162
v_and_b32 v197, 0xffff0000, v162
v_mfma_f32_32x32x16_bf16 v[48:63], a[212:215], v[168:171], v[48:63]
ds_read_b64_tr_b16 a[198:199], v21 offset:5120
ds_read_b64_tr_b16 a[200:201], v20 offset:6144
ds_read_b64_tr_b16 a[202:203], v20 offset:7168
v_lshlrev_b32 v198, 16, v163
v_and_b32 v199, 0xffff0000, v163
v_mfma_f32_32x32x16_bf16 v[32:47], a[216:219], v[172:175], v[32:47]
buffer_store_dwordx4 v[168:171], v26, s[24:27], s43 offen offset:2048 sc1
ds_read_b64_tr_b16 a[204:205], v21 offset:6144
ds_read_b64_tr_b16 a[206:207], v21 offset:7168
v_mfma_f32_32x32x16_bf16 v[48:63], a[220:223], v[172:175], v[48:63]
buffer_store_dwordx4 v[172:175], v26, s[24:27], s43 offen offset:3072 sc1
s_waitcnt vmcnt(0)
s_mov_b32 s44, 0
s_cmp_lg_u32 s32, 0
s_cbranch_scc0 L_m6_fl0x
buffer_store_dwordx2 v[6:7], v31, s[24:27], s44 offen
L_m6_fl0j:
s_mov_b32 s45, 0
buffer_load_dwordx2 v[0:1], v30, s[24:27], s45 offen sc1
s_waitcnt vmcnt(0)
L_m6_sp00:
v_cmp_eq_u64 vcc, s[48:49], v[0:1]
s_nop 1
s_and_b32 s44, vcc_lo, 127
s_cmp_eq_u32 s44, 127
s_cbranch_scc0 L_m6_ok00x
L_m6_ok00:
buffer_load_dwordx4 a[0:3], v26, s[76:79], s64 offen offset:0 sc1
buffer_load_dwordx4 a[4:7], v26, s[76:79], s64 offen offset:1024 sc1
buffer_load_dwordx4 a[8:11], v26, s[76:79], s64 offen offset:2048 sc1
buffer_load_dwordx4 a[12:15], v26, s[76:79], s64 offen offset:3072 sc1
s_waitcnt vmcnt(2) lgkmcnt(0)
v_mfma_f32_32x32x16_bf16 v[32:47], a[192:195], a[0:3], v[32:47]
ds_read_b64_tr_b16 a[208:209], v20 offset:8192
ds_read_b64_tr_b16 a[210:211], v20 offset:9216
ds_read_b64_tr_b16 a[212:213], v21 offset:8192
v_lshlrev_b32 v200, 16, v164
v_and_b32 v201, 0xffff0000, v164
v_mfma_f32_32x32x16_bf16 v[48:63], a[196:199], a[0:3], v[48:63]
buffer_load_dwordx4 a[16:19], v26, s[76:79], s65 offen offset:0 sc1
ds_read_b64_tr_b16 a[214:215], v21 offset:9216
ds_read_b64_tr_b16 a[216:217], v20 offset:10240
ds_read_b64_tr_b16 a[218:219], v20 offset:11264
v_mfma_f32_32x32x16_bf16 v[32:47], a[200:203], a[4:7], v[32:47]
buffer_load_dwordx4 a[20:23], v26, s[76:79], s65 offen offset:1024 sc1
ds_read_b64_tr_b16 a[220:221], v21 offset:10240
ds_read_b64_tr_b16 a[222:223], v21 offset:11264
v_mfma_f32_32x32x16_bf16 v[48:63], a[204:207], a[4:7], v[48:63]
buffer_load_dwordx4 a[24:27], v26, s[76:79], s65 offen offset:2048 sc1
s_waitcnt vmcnt(3) lgkmcnt(0)
v_mfma_f32_32x32x16_bf16 v[32:47], a[208:211], a[8:11], v[32:47]
s_barrier
ds_read_b64_tr_b16 a[192:193], v20 offset:12288
ds_read_b64_tr_b16 a[194:195], v20 offset:13312
v_mfma_f32_32x32x16_bf16 v[48:63], a[212:215], a[8:11], v[48:63]
buffer_load_dwordx4 a[28:31], v26, s[76:79], s65 offen offset:3072 sc1
ds_read_b64_tr_b16 a[196:197], v21 offset:12288
ds_read_b64_tr_b16 a[198:199], v21 offset:13312
ds_read_b64_tr_b16 a[200:201], v20 offset:14336
v_mfma_f32_32x32x16_bf16 v[32:47], a[216:219], a[12:15], v[32:47]
buffer_load_dwordx4 a[32:35], v26, s[76:79], s66 offen offset:0 sc1
ds_read_b64_tr_b16 a[202:203], v20 offset:15360
ds_read_b64_tr_b16 a[204:205], v21 offset:14336
ds_read_b64_tr_b16 a[206:207], v21 offset:15360
v_mfma_f32_32x32x16_bf16 v[48:63], a[220:223], a[12:15], v[48:63]
buffer_load_dwordx4 a[36:39], v26, s[76:79], s66 offen offset:1024 sc1
s_waitcnt vmcnt(4) lgkmcnt(0)
v_mfma_f32_32x32x16_bf16 v[32:47], a[192:195], a[16:19], v[32:47]
ds_read_b64_tr_b16 a[208:209], v20 offset:16384
ds_read_b64_tr_b16 a[210:211], v20 offset:17408
ds_read_b64_tr_b16 a[212:213], v21 offset:16384
v_lshlrev_b32 v202, 16, v165
v_and_b32 v203, 0xffff0000, v165
v_mfma_f32_32x32x16_bf16 v[48:63], a[196:199], a[16:19], v[48:63]
buffer_load_dwordx4 a[40:43], v26, s[76:79], s66 offen offset:2048 sc1
ds_read_b64_tr_b16 a[214:215], v21 offset:17408
ds_read_b64_tr_b16 a[216:217], v20 offset:18432
ds_read_b64_tr_b16 a[218:219], v20 offset:19456
v_mfma_f32_32x32x16_bf16 v[32:47], a[200:203], a[20:23], v[32:47]
buffer_load_dwordx4 a[44:47], v26, s[76:79], s66 offen offset:3072 sc1
ds_read_b64_tr_b16 a[220:221], v21 offset:18432
ds_read_b64_tr_b16 a[222:223], v21 offset:19456
v_mfma_f32_32x32x16_bf16 v[48:63], a[204:207], a[20:23], v[48:63]
buffer_load_dwordx4 a[48:51], v26, s[76:79], s67 offen offset:0 sc1
s_waitcnt vmcnt(5) lgkmcnt(0)
v_mfma_f32_32x32x16_bf16 v[32:47], a[208:211], a[24:27], v[32:47]
ds_read_b64_tr_b16 a[192:193], v20 offset:20480
ds_read_b64_tr_b16 a[194:195], v20 offset:21504
ds_read_b64_tr_b16 a[196:197], v21 offset:20480
v_lshlrev_b32 v204, 16, v166
v_and_b32 v205, 0xffff0000, v166
v_mfma_f32_32x32x16_bf16 v[48:63], a[212:215], a[24:27], v[48:63]
buffer_load_dwordx4 a[52:55], v26, s[76:79], s67 offen offset:1024 sc1
ds_read_b64_tr_b16 a[198:199], v21 offset:21504
ds_read_b64_tr_b16 a[200:201], v20 offset:22528
ds_read_b64_tr_b16 a[202:203], v20 offset:23552
v_lshlrev_b32 v206, 16, v167
v_mfma_f32_32x32x16_bf16 v[32:47], a[216:219], a[28:31], v[32:47]
buffer_load_dwordx4 a[56:59], v26, s[76:79], s67 offen offset:2048 sc1
ds_read_b64_tr_b16 a[204:205], v21 offset:22528
ds_read_b64_tr_b16 a[206:207], v21 offset:23552
v_mfma_f32_32x32x16_bf16 v[48:63], a[220:223], a[28:31], v[48:63]
buffer_load_dwordx4 a[60:63], v26, s[76:79], s67 offen offset:3072 sc1
s_waitcnt vmcnt(6) lgkmcnt(0)
v_mfma_f32_32x32x16_bf16 v[32:47], a[192:195], a[32:35], v[32:47]
ds_read_b64_tr_b16 a[208:209], v20 offset:24576
ds_read_b64_tr_b16 a[210:211], v20 offset:25600
ds_read_b64_tr_b16 a[212:213], v21 offset:24576
v_and_b32 v207, 0xffff0000, v167
v_lshlrev_b32 v208, 16, v168
v_mfma_f32_32x32x16_bf16 v[48:63], a[196:199], a[32:35], v[48:63]
buffer_load_dwordx4 a[64:67], v26, s[76:79], s68 offen offset:0 sc1
ds_read_b64_tr_b16 a[214:215], v21 offset:25600
ds_read_b64_tr_b16 a[216:217], v20 offset:26624
ds_read_b64_tr_b16 a[218:219], v20 offset:27648
v_mfma_f32_32x32x16_bf16 v[32:47], a[200:203], a[36:39], v[32:47]
buffer_load_dwordx4 a[68:71], v26, s[76:79], s68 offen offset:1024 sc1
ds_read_b64_tr_b16 a[220:221], v21 offset:26624
ds_read_b64_tr_b16 a[222:223], v21 offset:27648
v_and_b32 v209, 0xffff0000, v168
v_mfma_f32_32x32x16_bf16 v[48:63], a[204:207], a[36:39], v[48:63]
buffer_load_dwordx4 a[72:75], v26, s[76:79], s68 offen offset:2048 sc1
s_waitcnt vmcnt(7) lgkmcnt(0)
v_mfma_f32_32x32x16_bf16 v[32:47], a[208:211], a[40:43], v[32:47]
ds_read_b64_tr_b16 a[192:193], v20 offset:28672
ds_read_b64_tr_b16 a[194:195], v20 offset:29696
ds_read_b64_tr_b16 a[196:197], v21 offset:28672
v_lshlrev_b32 v210, 16, v169
v_and_b32 v211, 0xffff0000, v169
v_mfma_f32_32x32x16_bf16 v[48:63], a[212:215], a[40:43], v[48:63]
buffer_load_dwordx4 a[76:79], v26, s[76:79], s68 offen offset:3072 sc1
ds_read_b64_tr_b16 a[198:199], v21 offset:29696
ds_read_b64_tr_b16 a[200:201], v20 offset:30720
ds_read_b64_tr_b16 a[202:203], v20 offset:31744
v_mfma_f32_32x32x16_bf16 v[32:47], a[216:219], a[44:47], v[32:47]
buffer_load_dwordx4 a[80:83], v26, s[76:79], s69 offen offset:0 sc1
ds_read_b64_tr_b16 a[204:205], v21 offset:30720
ds_read_b64_tr_b16 a[206:207], v21 offset:31744
v_mfma_f32_32x32x16_bf16 v[48:63], a[220:223], a[44:47], v[48:63]
buffer_load_dwordx4 a[84:87], v26, s[76:79], s69 offen offset:1024 sc1
v_lshlrev_b32 v212, 16, v170
s_waitcnt vmcnt(8) lgkmcnt(0)
v_mfma_f32_32x32x16_bf16 v[32:47], a[192:195], a[48:51], v[32:47]
ds_read_b64_tr_b16 a[208:209], v20 offset:32768
ds_read_b64_tr_b16 a[210:211], v20 offset:33792
ds_read_b64_tr_b16 a[212:213], v21 offset:32768
v_and_b32 v213, 0xffff0000, v170
v_lshlrev_b32 v214, 16, v171
v_mfma_f32_32x32x16_bf16 v[48:63], a[196:199], a[48:51], v[48:63]
buffer_load_dwordx4 a[88:91], v26, s[76:79], s69 offen offset:2048 sc1
ds_read_b64_tr_b16 a[214:215], v21 offset:33792
ds_read_b64_tr_b16 a[216:217], v20 offset:34816
ds_read_b64_tr_b16 a[218:219], v20 offset:35840
v_mfma_f32_32x32x16_bf16 v[32:47], a[200:203], a[52:55], v[32:47]
s_mov_b32 s45, 16384
buffer_load_dwordx2 v[0:1], v30, s[24:27], s45 offen sc1
ds_read_b64_tr_b16 a[220:221], v21 offset:34816
ds_read_b64_tr_b16 a[222:223], v21 offset:35840
v_mfma_f32_32x32x16_bf16 v[48:63], a[204:207], a[52:55], v[48:63]
buffer_load_dwordx4 a[92:95], v26, s[76:79], s69 offen offset:3072 sc1
s_waitcnt vmcnt(9) lgkmcnt(0)
v_mfma_f32_32x32x16_bf16 v[32:47], a[208:211], a[56:59], v[32:47]
s_barrier
ds_read_b64_tr_b16 a[192:193], v20 offset:36864
ds_read_b64_tr_b16 a[194:195], v20 offset:37888
v_mfma_f32_32x32x16_bf16 v[48:63], a[212:215], a[56:59], v[48:63]
ds_read_b64_tr_b16 a[196:197], v21 offset:36864
ds_read_b64_tr_b16 a[198:199], v21 offset:37888
ds_read_b64_tr_b16 a[200:201], v20 offset:38912
v_and_b32 v215, 0xffff0000, v171
s_add_u32 m0, s41, 94208
v_mfma_f32_32x32x16_bf16 v[32:47], a[216:219], a[60:63], v[32:47]
buffer_load_dwordx4 v8, s[16:19], s62 offen lds
ds_read_b64_tr_b16 a[202:203], v20 offset:39936
ds_read_b64_tr_b16 a[204:205], v21 offset:38912
ds_read_b64_tr_b16 a[206:207], v21 offset:39936
s_add_u32 m0, s41, 98304
v_mfma_f32_32x32x16_bf16 v[48:63], a[220:223], a[60:63], v[48:63]
buffer_load_dwordx4 v10, s[16:19], s62 offen lds
v_lshlrev_b32 v216, 16, v172
s_waitcnt vmcnt(9) lgkmcnt(0)
v_mfma_f32_32x32x16_bf16 v[32:47], a[192:195], a[64:67], v[32:47]
ds_read_b64_tr_b16 a[208:209], v20 offset:40960
ds_read_b64_tr_b16 a[210:211], v20 offset:41984
ds_read_b64_tr_b16 a[212:213], v21 offset:40960
v_and_b32 v217, 0xffff0000, v172
v_lshlrev_b32 v218, 16, v173
v_mfma_f32_32x32x16_bf16 v[48:63], a[196:199], a[64:67], v[48:63]
ds_read_b64_tr_b16 a[214:215], v21 offset:41984
ds_read_b64_tr_b16 a[216:217], v20 offset:43008
ds_read_b64_tr_b16 a[218:219], v20 offset:44032
v_and_b32 v219, 0xffff0000, v173
s_add_u32 s16, s16, 1384448
s_addc_u32 s17, s17, 0
s_sub_u32 s18, s18, 1384448
s_add_u32 m0, s41, 102400
v_mfma_f32_32x32x16_bf16 v[32:47], a[200:203], a[68:71], v[32:47]
buffer_load_dwordx4 v8, s[16:19], s50 offen lds
ds_read_b64_tr_b16 a[220:221], v21 offset:43008
ds_read_b64_tr_b16 a[222:223], v21 offset:44032
s_add_u32 m0, s41, 106496
v_mfma_f32_32x32x16_bf16 v[48:63], a[204:207], a[68:71], v[48:63]
buffer_load_dwordx4 v10, s[16:19], s50 offen lds
s_waitcnt vmcnt(9) lgkmcnt(0)
v_mfma_f32_32x32x16_bf16 v[32:47], a[208:211], a[72:75], v[32:47]
ds_read_b64_tr_b16 a[192:193], v20 offset:45056
ds_read_b64_tr_b16 a[194:195], v20 offset:46080
ds_read_b64_tr_b16 a[196:197], v21 offset:45056
s_waitcnt vmcnt(5)
L_m6_sp01:
v_cmp_eq_u64 vcc, s[48:49], v[0:1]
s_nop 1
s_and_b32 s44, vcc_lo, 63
s_cmp_eq_u32 s44, 63
s_cbranch_scc0 L_m6_ok01x
L_m6_ok01:
v_mfma_f32_32x32x16_bf16 v[48:63], a[212:215], a[72:75], v[48:63]
ds_read_b64_tr_b16 a[198:199], v21 offset:46080
ds_read_b64_tr_b16 a[200:201], v20 offset:47104
ds_read_b64_tr_b16 a[202:203], v20 offset:48128
v_lshlrev_b32 v220, 16, v174
v_and_b32 v221, 0xffff0000, v174
v_mfma_f32_32x32x16_bf16 v[32:47], a[216:219], a[76:79], v[32:47]
buffer_load_dwordx4 a[96:99], v26, s[76:79], s70 offen offset:0 sc1
ds_read_b64_tr_b16 a[204:205], v21 offset:47104
ds_read_b64_tr_b16 a[206:207], v21 offset:48128
v_mfma_f32_32x32x16_bf16 v[48:63], a[220:223], a[76:79], v[48:63]
buffer_load_dwordx4 a[100:103], v26, s[76:79], s70 offen offset:1024 sc1
s_waitcnt lgkmcnt(0)
v_mfma_f32_32x32x16_bf16 v[32:47], a[192:195], a[80:83], v[32:47]
ds_read_b64_tr_b16 a[208:209], v20 offset:49152
ds_read_b64_tr_b16 a[210:211], v20 offset:50176
ds_read_b64_tr_b16 a[212:213], v21 offset:49152
v_lshlrev_b32 v222, 16, v175
v_and_b32 v223, 0xffff0000, v175
v_mfma_f32_32x32x16_bf16 v[48:63], a[196:199], a[80:83], v[48:63]
buffer_load_dwordx4 a[104:107], v26, s[76:79], s70 offen offset:2048 sc1
ds_read_b64_tr_b16 a[214:215], v21 offset:50176
ds_read_b64_tr_b16 a[216:217], v20 offset:51200
ds_read_b64_tr_b16 a[218:219], v20 offset:52224
v_mfma_f32_32x32x16_bf16 v[32:47], a[200:203], a[84:87], v[32:47]
buffer_load_dwordx4 a[108:111], v26, s[76:79], s70 offen offset:3072 sc1
ds_read_b64_tr_b16 a[220:221], v21 offset:51200
ds_read_b64_tr_b16 a[222:223], v21 offset:52224
v_mfma_f32_32x32x16_bf16 v[48:63], a[204:207], a[84:87], v[48:63]
buffer_load_dwordx4 a[112:115], v26, s[76:79], s71 offen offset:0 sc1
s_waitcnt vmcnt(9) lgkmcnt(0)
v_mfma_f32_32x32x16_bf16 v[32:47], a[208:211], a[88:91], v[32:47]
ds_read_b64_tr_b16 a[192:193], v20 offset:53248
ds_read_b64_tr_b16 a[194:195], v20 offset:54272
ds_read_b64_tr_b16 a[196:197], v21 offset:53248
v_mfma_f32_32x32x16_bf16 v[48:63], a[212:215], a[88:91], v[48:63]
s_mov_b32 s44, 81920
s_cmp_lg_u32 s32, 0
s_cbranch_scc0 L_m6_fl5x
buffer_store_dwordx2 v[6:7], v31, s[24:27], s44 offen
L_m6_fl5j:
ds_read_b64_tr_b16 a[198:199], v21 offset:54272
ds_read_b64_tr_b16 a[200:201], v20 offset:55296
ds_read_b64_tr_b16 a[202:203], v20 offset:56320
v_mfma_f32_32x32x16_bf16 v[32:47], a[216:219], a[92:95], v[32:47]
buffer_load_dwordx4 a[116:119], v26, s[76:79], s71 offen offset:1024 sc1
ds_read_b64_tr_b16 a[204:205], v21 offset:55296
ds_read_b64_tr_b16 a[206:207], v21 offset:56320
v_mfma_f32_32x32x16_bf16 v[48:63], a[220:223], a[92:95], v[48:63]
buffer_load_dwordx4 a[120:123], v26, s[76:79], s71 offen offset:2048 sc1
s_waitcnt vmcnt(6) lgkmcnt(0)
v_mfma_f32_32x32x16_bf16 v[32:47], a[192:195], a[96:99], v[32:47]
ds_read_b64_tr_b16 a[208:209], v20 offset:57344
ds_read_b64_tr_b16 a[210:211], v20 offset:58368
ds_read_b64_tr_b16 a[212:213], v21 offset:57344
v_mfma_f32_32x32x16_bf16 v[48:63], a[196:199], a[96:99], v[48:63]
s_mov_b32 s45, 81920
buffer_load_dwordx2 v[0:1], v30, s[24:27], s45 offen sc1
ds_read_b64_tr_b16 a[214:215], v21 offset:58368
ds_read_b64_tr_b16 a[216:217], v20 offset:59392
ds_read_b64_tr_b16 a[218:219], v20 offset:60416
v_mfma_f32_32x32x16_bf16 v[32:47], a[200:203], a[100:103], v[32:47]
buffer_load_dwordx4 a[124:127], v26, s[76:79], s71 offen offset:3072 sc1
ds_read_b64_tr_b16 a[220:221], v21 offset:59392
ds_read_b64_tr_b16 a[222:223], v21 offset:60416
v_mfma_f32_32x32x16_bf16 v[48:63], a[204:207], a[100:103], v[48:63]
buffer_load_dwordx4 a[128:131], v26, s[76:79], s72 offen offset:0 sc1
s_waitcnt vmcnt(7) lgkmcnt(0)
v_mfma_f32_32x32x16_bf16 v[32:47], a[208:211], a[104:107], v[32:47]
s_barrier
ds_read_b64_tr_b16 a[192:193], v20 offset:61440
ds_read_b64_tr_b16 a[194:195], v20 offset:62464
v_mfma_f32_32x32x16_bf16 v[48:63], a[212:215], a[104:107], v[48:63]
buffer_load_dwordx4 a[132:135], v26, s[76:79], s72 offen offset:1024 sc1
ds_read_b64_tr_b16 a[196:197], v21 offset:61440
ds_read_b64_tr_b16 a[198:199], v21 offset:62464
ds_read_b64_tr_b16 a[200:201], v20 offset:63488
v_mfma_f32_32x32x16_bf16 v[32:47], a[216:219], a[108:111], v[32:47]
buffer_load_dwordx4 a[136:139], v26, s[76:79], s72 offen offset:2048 sc1
ds_read_b64_tr_b16 a[202:203], v20 offset:64512
ds_read_b64_tr_b16 a[204:205], v21 offset:63488
ds_read_b64_tr_b16 a[206:207], v21 offset:64512
v_mfma_f32_32x32x16_bf16 v[48:63], a[220:223], a[108:111], v[48:63]
buffer_load_dwordx4 a[140:143], v26, s[76:79], s72 offen offset:3072 sc1
s_waitcnt vmcnt(7) lgkmcnt(0)
v_mfma_f32_32x32x16_bf16 v[32:47], a[192:195], a[112:115], v[32:47]
ds_read_b64_tr_b16 a[208:209], v22 offset:0
ds_read_b64_tr_b16 a[210:211], v22 offset:1024
ds_read_b64_tr_b16 a[212:213], v23 offset:0
v_mfma_f32_32x32x16_bf16 v[48:63], a[196:199], a[112:115], v[48:63]
buffer_load_dwordx4 a[144:147], v26, s[76:79], s73 offen offset:0 sc1
ds_read_b64_tr_b16 a[214:215], v23 offset:1024
ds_read_b64_tr_b16 a[216:217], v22 offset:2048
ds_read_b64_tr_b16 a[218:219], v22 offset:3072
v_mfma_f32_32x32x16_bf16 v[32:47], a[200:203], a[116:119], v[32:47]
buffer_load_dwordx4 a[148:151], v26, s[76:79], s73 offen offset:1024 sc1
ds_read_b64_tr_b16 a[220:221], v23 offset:2048
ds_read_b64_tr_b16 a[222:223], v23 offset:3072
v_mfma_f32_32x32x16_bf16 v[48:63], a[204:207], a[116:119], v[48:63]
buffer_load_dwordx4 a[152:155], v26, s[76:79], s73 offen offset:2048 sc1
s_waitcnt vmcnt(7) lgkmcnt(0)
v_mfma_f32_32x32x16_bf16 v[32:47], a[208:211], a[120:123], v[32:47]
ds_read_b64_tr_b16 a[192:193], v22 offset:4096
ds_read_b64_tr_b16 a[194:195], v22 offset:5120
ds_read_b64_tr_b16 a[196:197], v23 offset:4096
L_m6_sp88:
v_cmp_eq_u64 vcc, s[48:49], v[0:1]
s_nop 1
s_and_b32 s44, vcc_lo, 127
s_cmp_eq_u32 s44, 127
s_cbranch_scc0 L_m6_ok88x
L_m6_ok88:
v_mfma_f32_32x32x16_bf16 v[48:63], a[212:215], a[120:123], v[48:63]
buffer_load_dwordx4 a[156:159], v26, s[76:79], s73 offen offset:3072 sc1
ds_read_b64_tr_b16 a[198:199], v23 offset:5120
ds_read_b64_tr_b16 a[200:201], v22 offset:6144
ds_read_b64_tr_b16 a[202:203], v22 offset:7168
s_add_u32 m0, s41, 0
v_mfma_f32_32x32x16_bf16 v[32:47], a[216:219], a[124:127], v[32:47]
buffer_load_dwordx4 v8, s[16:19], s51 offen lds
ds_read_b64_tr_b16 a[204:205], v23 offset:6144
ds_read_b64_tr_b16 a[206:207], v23 offset:7168
v_mfma_f32_32x32x16_bf16 v[48:63], a[220:223], a[124:127], v[48:63]
buffer_load_dwordx4 a[160:163], v26, s[76:79], s74 offen offset:0 sc1
s_waitcnt vmcnt(8) lgkmcnt(0)
v_mfma_f32_32x32x16_bf16 v[32:47], a[192:195], a[128:131], v[32:47]
ds_read_b64_tr_b16 a[208:209], v22 offset:8192
ds_read_b64_tr_b16 a[210:211], v22 offset:9216
ds_read_b64_tr_b16 a[212:213], v23 offset:8192
ds_read_b128 v[224:227], v29 offset:1024
ds_read_b128 v[228:231], v29 offset:1056
v_mfma_f32_32x32x16_bf16 v[48:63], a[196:199], a[128:131], v[48:63]
buffer_load_dwordx4 a[164:167], v26, s[76:79], s74 offen offset:1024 sc1
ds_read_b64_tr_b16 a[214:215], v23 offset:9216
ds_read_b64_tr_b16 a[216:217], v22 offset:10240
ds_read_b64_tr_b16 a[218:219], v22 offset:11264
s_add_u32 m0, s41, 4096
v_mfma_f32_32x32x16_bf16 v[32:47], a[200:203], a[132:135], v[32:47]
buffer_load_dwordx4 v10, s[16:19], s51 offen lds
ds_read_b64_tr_b16 a[220:221], v23 offset:10240
ds_read_b64_tr_b16 a[222:223], v23 offset:11264
v_mfma_f32_32x32x16_bf16 v[48:63], a[204:207], a[132:135], v[48:63]
buffer_load_dwordx4 a[168:171], v26, s[76:79], s74 offen offset:2048 sc1
ds_read_b128 v[232:235], v29 offset:1088
s_waitcnt vmcnt(9) lgkmcnt(1)
v_mfma_f32_32x32x16_bf16 v[32:47], a[208:211], a[136:139], v[32:47]
ds_read_b64_tr_b16 a[192:193], v22 offset:12288
ds_read_b64_tr_b16 a[194:195], v22 offset:13312
ds_read_b64_tr_b16 a[196:197], v23 offset:12288
ds_read_b128 v[236:239], v29 offset:1120
ds_read_b128 v[240:243], v29 offset:1152
v_mfma_f32_32x32x16_bf16 v[48:63], a[212:215], a[136:139], v[48:63]
buffer_load_dwordx4 a[172:175], v26, s[76:79], s74 offen offset:3072 sc1
ds_read_b64_tr_b16 a[198:199], v23 offset:13312
ds_read_b64_tr_b16 a[200:201], v22 offset:14336
ds_read_b64_tr_b16 a[202:203], v22 offset:15360
s_add_u32 m0, s41, 114688
v_mfma_f32_32x32x16_bf16 v[32:47], a[216:219], a[140:143], v[32:47]
buffer_load_dwordx4 v8, s[16:19], s52 offen lds
ds_read_b64_tr_b16 a[204:205], v23 offset:14336
ds_read_b64_tr_b16 a[206:207], v23 offset:15360
v_mfma_f32_32x32x16_bf16 v[48:63], a[220:223], a[140:143], v[48:63]
buffer_load_dwordx4 a[176:179], v26, s[76:79], s75 offen offset:0 sc1
ds_read_b128 v[244:247], v29 offset:1184
s_waitcnt vmcnt(10) lgkmcnt(1)
v_mfma_f32_32x32x16_bf16 v[32:47], a[192:195], a[144:147], v[32:47]
ds_read_b64_tr_b16 a[208:209], v22 offset:16384
ds_read_b64_tr_b16 a[210:211], v22 offset:17408
ds_read_b64_tr_b16 a[212:213], v23 offset:16384
ds_read_b128 v[248:251], v29 offset:1216
ds_read_b128 v[252:255], v29 offset:1248
v_mfma_f32_32x32x16_bf16 v[48:63], a[196:199], a[144:147], v[48:63]
buffer_load_dwordx4 a[180:183], v26, s[76:79], s75 offen offset:1024 sc1
ds_read_b64_tr_b16 a[214:215], v23 offset:17408
ds_read_b64_tr_b16 a[216:217], v22 offset:18432
ds_read_b64_tr_b16 a[218:219], v22 offset:19456
s_add_u32 m0, s41, 118784
v_mfma_f32_32x32x16_bf16 v[32:47], a[200:203], a[148:151], v[32:47]
buffer_load_dwordx4 v10, s[16:19], s52 offen lds
ds_read_b64_tr_b16 a[220:221], v23 offset:18432
ds_read_b64_tr_b16 a[222:223], v23 offset:19456
v_mfma_f32_32x32x16_bf16 v[48:63], a[204:207], a[148:151], v[48:63]
buffer_load_dwordx4 a[184:187], v26, s[76:79], s75 offen offset:2048 sc1
s_waitcnt vmcnt(11) lgkmcnt(0)
v_mfma_f32_32x32x16_bf16 v[32:47], a[208:211], a[152:155], v[32:47]
s_barrier
ds_read_b64_tr_b16 a[192:193], v22 offset:20480
ds_read_b64_tr_b16 a[194:195], v22 offset:21504
v_mfma_f32_32x32x16_bf16 v[48:63], a[212:215], a[152:155], v[48:63]
buffer_load_dwordx4 a[188:191], v26, s[76:79], s75 offen offset:3072 sc1
ds_read_b64_tr_b16 a[196:197], v23 offset:20480
ds_read_b64_tr_b16 a[198:199], v23 offset:21504
ds_read_b64_tr_b16 a[200:201], v22 offset:22528
s_add_u32 m0, s41, 126976
v_mfma_f32_32x32x16_bf16 v[32:47], a[216:219], a[156:159], v[32:47]
buffer_load_dwordx4 v8, s[16:19], s53 offen lds
ds_read_b64_tr_b16 a[202:203], v22 offset:23552
ds_read_b64_tr_b16 a[204:205], v23 offset:22528
ds_read_b64_tr_b16 a[206:207], v23 offset:23552
s_add_u32 m0, s41, 131072
v_mfma_f32_32x32x16_bf16 v[48:63], a[220:223], a[156:159], v[48:63]
buffer_load_dwordx4 v10, s[16:19], s53 offen lds
s_waitcnt vmcnt(11) lgkmcnt(0)
v_mfma_f32_32x32x16_bf16 v[32:47], a[192:195], a[160:163], v[32:47]
ds_read_b64_tr_b16 a[208:209], v22 offset:24576
ds_read_b64_tr_b16 a[210:211], v22 offset:25600
ds_read_b64_tr_b16 a[212:213], v23 offset:24576
s_add_u32 m0, s41, 139264
v_mfma_f32_32x32x16_bf16 v[48:63], a[196:199], a[160:163], v[48:63]
buffer_load_dwordx4 v8, s[16:19], s54 offen lds
ds_read_b64_tr_b16 a[214:215], v23 offset:25600
ds_read_b64_tr_b16 a[216:217], v22 offset:26624
ds_read_b64_tr_b16 a[218:219], v22 offset:27648
s_add_u32 m0, s41, 143360
v_mfma_f32_32x32x16_bf16 v[32:47], a[200:203], a[164:167], v[32:47]
buffer_load_dwordx4 v10, s[16:19], s54 offen lds
ds_read_b64_tr_b16 a[220:221], v23 offset:26624
ds_read_b64_tr_b16 a[222:223], v23 offset:27648
s_add_u32 m0, s41, 151552
v_mfma_f32_32x32x16_bf16 v[48:63], a[204:207], a[164:167], v[48:63]
buffer_load_dwordx4 v8, s[16:19], s55 offen lds
s_waitcnt vmcnt(11) lgkmcnt(0)
v_mfma_f32_32x32x16_bf16 v[32:47], a[208:211], a[168:171], v[32:47]
ds_read_b64_tr_b16 a[192:193], v22 offset:28672
ds_read_b64_tr_b16 a[194:195], v22 offset:29696
ds_read_b64_tr_b16 a[196:197], v23 offset:28672
v_mfma_f32_32x32x16_bf16 v[48:63], a[212:215], a[168:171], v[48:63]
ds_read_b64_tr_b16 a[198:199], v23 offset:29696
ds_read_b64_tr_b16 a[200:201], v22 offset:30720
ds_read_b64_tr_b16 a[202:203], v22 offset:31744
s_add_u32 m0, s41, 155648
v_mfma_f32_32x32x16_bf16 v[32:47], a[216:219], a[172:175], v[32:47]
buffer_load_dwordx4 v10, s[16:19], s55 offen lds
ds_read_b64_tr_b16 a[204:205], v23 offset:30720
ds_read_b64_tr_b16 a[206:207], v23 offset:31744
s_add_u32 m0, s41, 8192
v_mfma_f32_32x32x16_bf16 v[48:63], a[220:223], a[172:175], v[48:63]
buffer_load_dwordx4 v8, s[16:19], s56 offen lds
s_waitcnt vmcnt(10) lgkmcnt(0)
v_mfma_f32_32x32x16_bf16 v[32:47], a[192:195], a[176:179], v[32:47]
ds_read_b64_tr_b16 a[208:209], v22 offset:32768
ds_read_b64_tr_b16 a[210:211], v22 offset:33792
ds_read_b64_tr_b16 a[212:213], v23 offset:32768
v_mfma_f32_32x32x16_bf16 v[48:63], a[196:199], a[176:179], v[48:63]
ds_read_b64_tr_b16 a[214:215], v23 offset:33792
ds_read_b64_tr_b16 a[216:217], v22 offset:34816
ds_read_b64_tr_b16 a[218:219], v22 offset:35840
s_add_u32 m0, s41, 12288
v_mfma_f32_32x32x16_bf16 v[32:47], a[200:203], a[180:183], v[32:47]
buffer_load_dwordx4 v10, s[16:19], s56 offen lds
ds_read_b64_tr_b16 a[220:221], v23 offset:34816
ds_read_b64_tr_b16 a[222:223], v23 offset:35840
s_add_u32 m0, s41, 16384
v_mfma_f32_32x32x16_bf16 v[48:63], a[204:207], a[180:183], v[48:63]
buffer_load_dwordx4 v8, s[16:19], s57 offen lds
s_waitcnt vmcnt(9) lgkmcnt(0)
v_mfma_f32_32x32x16_bf16 v[32:47], a[208:211], a[184:187], v[32:47]
ds_read_b64_tr_b16 a[192:193], v22 offset:36864
ds_read_b64_tr_b16 a[194:195], v22 offset:37888
ds_read_b64_tr_b16 a[196:197], v23 offset:36864
v_mfma_f32_32x32x16_bf16 v[48:63], a[212:215], a[184:187], v[48:63]
ds_read_b64_tr_b16 a[198:199], v23 offset:37888
ds_read_b64_tr_b16 a[200:201], v22 offset:38912
ds_read_b64_tr_b16 a[202:203], v22 offset:39936
s_add_u32 m0, s41, 20480
v_mfma_f32_32x32x16_bf16 v[32:47], a[216:219], a[188:191], v[32:47]
buffer_load_dwordx4 v10, s[16:19], s57 offen lds
ds_read_b64_tr_b16 a[204:205], v23 offset:38912
ds_read_b64_tr_b16 a[206:207], v23 offset:39936
s_add_u32 m0, s41, 24576
v_mfma_f32_32x32x16_bf16 v[48:63], a[220:223], a[188:191], v[48:63]
buffer_load_dwordx4 v8, s[16:19], s58 offen lds
s_nop 5
v_fma_f32 v32, v96, v32, v192
v_fma_f32 v33, v97, v33, v193
v_cvt_pk_bf16_f32 v160, v32, v33
v_fma_f32 v34, v98, v34, v194
v_fma_f32 v35, v99, v35, v195
v_cvt_pk_bf16_f32 v161, v34, v35
v_fma_f32 v36, v100, v36, v196
v_fma_f32 v37, v101, v37, v197
v_cvt_pk_bf16_f32 v162, v36, v37
v_fma_f32 v38, v102, v38, v198
v_fma_f32 v39, v103, v39, v199
v_cvt_pk_bf16_f32 v163, v38, v39
v_fma_f32 v40, v104, v40, v200
v_fma_f32 v41, v105, v41, v201
v_cvt_pk_bf16_f32 v164, v40, v41
v_fma_f32 v42, v106, v42, v202
v_fma_f32 v43, v107, v43, v203
v_cvt_pk_bf16_f32 v165, v42, v43
v_fma_f32 v44, v108, v44, v204
v_fma_f32 v45, v109, v45, v205
v_cvt_pk_bf16_f32 v166, v44, v45
v_fma_f32 v46, v110, v46, v206
v_fma_f32 v47, v111, v47, v207
v_cvt_pk_bf16_f32 v167, v46, v47
v_fma_f32 v48, v112, v48, v208
v_fma_f32 v49, v113, v49, v209
v_cvt_pk_bf16_f32 v168, v48, v49
v_fma_f32 v50, v114, v50, v210
v_fma_f32 v51, v115, v51, v211
v_cvt_pk_bf16_f32 v169, v50, v51
v_fma_f32 v52, v116, v52, v212
v_fma_f32 v53, v117, v53, v213
v_cvt_pk_bf16_f32 v170, v52, v53
v_fma_f32 v54, v118, v54, v214
v_fma_f32 v55, v119, v55, v215
v_cvt_pk_bf16_f32 v171, v54, v55
v_fma_f32 v56, v120, v56, v216
v_fma_f32 v57, v121, v57, v217
v_cvt_pk_bf16_f32 v172, v56, v57
v_fma_f32 v58, v122, v58, v218
v_fma_f32 v59, v123, v59, v219
v_cvt_pk_bf16_f32 v173, v58, v59
v_fma_f32 v60, v124, v60, v220
v_fma_f32 v61, v125, v61, v221
v_cvt_pk_bf16_f32 v174, v60, v61
v_fma_f32 v62, v126, v62, v222
v_fma_f32 v63, v127, v63, v223
v_cvt_pk_bf16_f32 v175, v62, v63
s_waitcnt lgkmcnt(0)
v_mfma_f32_32x32x16_bf16 v[32:47], a[192:195], v[160:163], v[224:239]
ds_read_b64_tr_b16 a[208:209], v22 offset:40960
ds_read_b64_tr_b16 a[210:211], v22 offset:41984
ds_read_b64_tr_b16 a[212:213], v23 offset:40960
v_lshlrev_b32 v192, 16, v160
v_and_b32 v193, 0xffff0000, v160
v_mfma_f32_32x32x16_bf16 v[48:63], a[196:199], v[160:163], v[240:255]
ds_read_b64_tr_b16 a[214:215], v23 offset:41984
ds_read_b64_tr_b16 a[216:217], v22 offset:43008
ds_read_b64_tr_b16 a[218:219], v22 offset:44032
v_lshlrev_b32 v194, 16, v161
v_and_b32 v195, 0xffff0000, v161
v_mfma_f32_32x32x16_bf16 v[32:47], a[200:203], v[164:167], v[32:47]
s_add_u32 s43, s63, 16777216
s_add_u32 s43, s43, s93
s_cmp_lg_u32 s32, 0
s_cbranch_scc0 L_m6_st100x
buffer_store_dwordx4 v[160:163], v26, s[24:27], s43 offen offset:0
L_m6_st100j:
ds_read_b64_tr_b16 a[220:221], v23 offset:43008
ds_read_b64_tr_b16 a[222:223], v23 offset:44032
v_mfma_f32_32x32x16_bf16 v[48:63], a[204:207], v[164:167], v[48:63]
s_cmp_lg_u32 s32, 0
s_cbranch_scc0 L_m6_st101x
buffer_store_dwordx4 v[164:167], v26, s[24:27], s43 offen offset:1024
L_m6_st101j:
s_waitcnt vmcnt(11) lgkmcnt(0)
v_mfma_f32_32x32x16_bf16 v[32:47], a[208:211], v[168:171], v[32:47]
s_barrier
ds_read_b64_tr_b16 a[192:193], v20 offset:0
ds_read_b64_tr_b16 a[194:195], v20 offset:1024
v_mfma_f32_32x32x16_bf16 v[48:63], a[212:215], v[168:171], v[48:63]
ds_read_b64_tr_b16 a[196:197], v21 offset:0
ds_read_b64_tr_b16 a[198:199], v21 offset:1024
ds_read_b64_tr_b16 a[200:201], v20 offset:2048
v_lshlrev_b32 v196, 16, v162
v_and_b32 v197, 0xffff0000, v162
v_mfma_f32_32x32x16_bf16 v[32:47], a[216:219], v[172:175], v[32:47]
s_cmp_lg_u32 s32, 0
s_cbranch_scc0 L_m6_st102x
buffer_store_dwordx4 v[168:171], v26, s[24:27], s43 offen offset:2048
L_m6_st102j:
ds_read_b64_tr_b16 a[202:203], v20 offset:3072
ds_read_b64_tr_b16 a[204:205], v21 offset:2048
ds_read_b64_tr_b16 a[206:207], v21 offset:3072
v_mfma_f32_32x32x16_bf16 v[48:63], a[220:223], v[172:175], v[48:63]
s_cmp_lg_u32 s32, 0
s_cbranch_scc0 L_m6_st103x
buffer_store_dwordx4 v[172:175], v26, s[24:27], s43 offen offset:3072
L_m6_st103j:
s_waitcnt vmcnt(0)
s_mov_b32 s44, 32768
s_cmp_lg_u32 s32, 0
s_cbranch_scc0 L_m6_fl2x
buffer_store_dwordx2 v[6:7], v31, s[24:27], s44 offen
L_m6_fl2j:
s_mov_b32 s45, 32768
buffer_load_dwordx2 v[0:1], v30, s[24:27], s45 offen sc1
s_waitcnt vmcnt(0)
L_m6_sp10:
v_cmp_eq_u64 vcc, s[48:49], v[0:1]
s_nop 1
s_and_b32 s44, vcc_lo, 127
s_cmp_eq_u32 s44, 127
s_cbranch_scc0 L_m6_ok10x
L_m6_ok10:
s_add_u32 s76, s76, s93
s_addc_u32 s77, s77, 0
buffer_load_dwordx4 a[0:3], v26, s[76:79], s64 offen offset:0 sc1
buffer_load_dwordx4 a[4:7], v26, s[76:79], s64 offen offset:1024 sc1
buffer_load_dwordx4 a[8:11], v26, s[76:79], s64 offen offset:2048 sc1
buffer_load_dwordx4 a[12:15], v26, s[76:79], s64 offen offset:3072 sc1
s_waitcnt vmcnt(2) lgkmcnt(0)
v_mfma_f32_32x32x16_bf16 v[32:47], a[192:195], a[0:3], v[32:47]
ds_read_b64_tr_b16 a[208:209], v20 offset:4096
ds_read_b64_tr_b16 a[210:211], v20 offset:5120
ds_read_b64_tr_b16 a[212:213], v21 offset:4096
v_lshlrev_b32 v198, 16, v163
v_and_b32 v199, 0xffff0000, v163
v_mfma_f32_32x32x16_bf16 v[48:63], a[196:199], a[0:3], v[48:63]
buffer_load_dwordx4 a[16:19], v26, s[76:79], s65 offen offset:0 sc1
ds_read_b64_tr_b16 a[214:215], v21 offset:5120
ds_read_b64_tr_b16 a[216:217], v20 offset:6144
ds_read_b64_tr_b16 a[218:219], v20 offset:7168
v_mfma_f32_32x32x16_bf16 v[32:47], a[200:203], a[4:7], v[32:47]
buffer_load_dwordx4 a[20:23], v26, s[76:79], s65 offen offset:1024 sc1
ds_read_b64_tr_b16 a[220:221], v21 offset:6144
ds_read_b64_tr_b16 a[222:223], v21 offset:7168
v_mfma_f32_32x32x16_bf16 v[48:63], a[204:207], a[4:7], v[48:63]
buffer_load_dwordx4 a[24:27], v26, s[76:79], s65 offen offset:2048 sc1
s_waitcnt vmcnt(3) lgkmcnt(0)
v_mfma_f32_32x32x16_bf16 v[32:47], a[208:211], a[8:11], v[32:47]
ds_read_b64_tr_b16 a[192:193], v22 offset:49152
ds_read_b64_tr_b16 a[194:195], v22 offset:50176
ds_read_b64_tr_b16 a[196:197], v23 offset:49152
v_lshlrev_b32 v200, 16, v164
v_and_b32 v201, 0xffff0000, v164
v_mfma_f32_32x32x16_bf16 v[48:63], a[212:215], a[8:11], v[48:63]
buffer_load_dwordx4 a[28:31], v26, s[76:79], s65 offen offset:3072 sc1
ds_read_b64_tr_b16 a[198:199], v23 offset:50176
ds_read_b64_tr_b16 a[200:201], v22 offset:51200
ds_read_b64_tr_b16 a[202:203], v22 offset:52224
v_mfma_f32_32x32x16_bf16 v[32:47], a[216:219], a[12:15], v[32:47]
buffer_load_dwordx4 a[32:35], v26, s[76:79], s66 offen offset:0 sc1
ds_read_b64_tr_b16 a[204:205], v23 offset:51200
ds_read_b64_tr_b16 a[206:207], v23 offset:52224
v_mfma_f32_32x32x16_bf16 v[48:63], a[220:223], a[12:15], v[48:63]
buffer_load_dwordx4 a[36:39], v26, s[76:79], s66 offen offset:1024 sc1
s_waitcnt vmcnt(4) lgkmcnt(0)
v_mfma_f32_32x32x16_bf16 v[32:47], a[192:195], a[16:19], v[32:47]
ds_read_b64_tr_b16 a[208:209], v22 offset:53248
ds_read_b64_tr_b16 a[210:211], v22 offset:54272
ds_read_b64_tr_b16 a[212:213], v23 offset:53248
v_lshlrev_b32 v202, 16, v165
v_and_b32 v203, 0xffff0000, v165
v_mfma_f32_32x32x16_bf16 v[48:63], a[196:199], a[16:19], v[48:63]
buffer_load_dwordx4 a[40:43], v26, s[76:79], s66 offen offset:2048 sc1
ds_read_b64_tr_b16 a[214:215], v23 offset:54272
ds_read_b64_tr_b16 a[216:217], v22 offset:55296
ds_read_b64_tr_b16 a[218:219], v22 offset:56320
v_mfma_f32_32x32x16_bf16 v[32:47], a[200:203], a[20:23], v[32:47]
buffer_load_dwordx4 a[44:47], v26, s[76:79], s66 offen offset:3072 sc1
ds_read_b64_tr_b16 a[220:221], v23 offset:55296
ds_read_b64_tr_b16 a[222:223], v23 offset:56320
v_mfma_f32_32x32x16_bf16 v[48:63], a[204:207], a[20:23], v[48:63]
buffer_load_dwordx4 a[48:51], v26, s[76:79], s67 offen offset:0 sc1
s_waitcnt vmcnt(5) lgkmcnt(0)
v_mfma_f32_32x32x16_bf16 v[32:47], a[208:211], a[24:27], v[32:47]
ds_read_b64_tr_b16 a[192:193], v22 offset:61440
ds_read_b64_tr_b16 a[194:195], v22 offset:62464
ds_read_b64_tr_b16 a[196:197], v23 offset:61440
v_lshlrev_b32 v204, 16, v166
v_and_b32 v205, 0xffff0000, v166
v_mfma_f32_32x32x16_bf16 v[48:63], a[212:215], a[24:27], v[48:63]
buffer_load_dwordx4 a[52:55], v26, s[76:79], s67 offen offset:1024 sc1
ds_read_b64_tr_b16 a[198:199], v23 offset:62464
ds_read_b64_tr_b16 a[200:201], v22 offset:63488
ds_read_b64_tr_b16 a[202:203], v22 offset:64512
v_mfma_f32_32x32x16_bf16 v[32:47], a[216:219], a[28:31], v[32:47]
buffer_load_dwordx4 a[56:59], v26, s[76:79], s67 offen offset:2048 sc1
ds_read_b64_tr_b16 a[204:205], v23 offset:63488
ds_read_b64_tr_b16 a[206:207], v23 offset:64512
v_lshlrev_b32 v206, 16, v167
v_mfma_f32_32x32x16_bf16 v[48:63], a[220:223], a[28:31], v[48:63]
buffer_load_dwordx4 a[60:63], v26, s[76:79], s67 offen offset:3072 sc1
s_waitcnt vmcnt(6) lgkmcnt(0)
v_mfma_f32_32x32x16_bf16 v[32:47], a[192:195], a[32:35], v[32:47]
ds_read_b64_tr_b16 a[208:209], v24 offset:0
ds_read_b64_tr_b16 a[210:211], v24 offset:1024
ds_read_b64_tr_b16 a[212:213], v25 offset:0
v_and_b32 v207, 0xffff0000, v167
v_lshlrev_b32 v208, 16, v168
v_mfma_f32_32x32x16_bf16 v[48:63], a[196:199], a[32:35], v[48:63]
buffer_load_dwordx4 a[64:67], v26, s[76:79], s68 offen offset:0 sc1
ds_read_b64_tr_b16 a[214:215], v25 offset:1024
ds_read_b64_tr_b16 a[216:217], v24 offset:2048
ds_read_b64_tr_b16 a[218:219], v24 offset:3072
v_mfma_f32_32x32x16_bf16 v[32:47], a[200:203], a[36:39], v[32:47]
buffer_load_dwordx4 a[68:71], v26, s[76:79], s68 offen offset:1024 sc1
ds_read_b64_tr_b16 a[220:221], v25 offset:2048
ds_read_b64_tr_b16 a[222:223], v25 offset:3072
v_and_b32 v209, 0xffff0000, v168
s_add_u32 m0, s41, 28672
v_mfma_f32_32x32x16_bf16 v[48:63], a[204:207], a[36:39], v[48:63]
buffer_load_dwordx4 v10, s[16:19], s58 offen lds
s_waitcnt vmcnt(7) lgkmcnt(0)
v_mfma_f32_32x32x16_bf16 v[32:47], a[208:211], a[40:43], v[32:47]
s_barrier
ds_read_b64_tr_b16 a[192:193], v24 offset:8192
ds_read_b64_tr_b16 a[194:195], v24 offset:9216
v_mfma_f32_32x32x16_bf16 v[48:63], a[212:215], a[40:43], v[48:63]
s_mov_b32 s45, 49152
buffer_load_dwordx2 v[0:1], v30, s[24:27], s45 offen sc1
ds_read_b64_tr_b16 a[196:197], v25 offset:8192
ds_read_b64_tr_b16 a[198:199], v25 offset:9216
ds_read_b64_tr_b16 a[200:201], v24 offset:10240
v_mfma_f32_32x32x16_bf16 v[32:47], a[216:219], a[44:47], v[32:47]
buffer_load_dwordx4 a[72:75], v26, s[76:79], s68 offen offset:2048 sc1
ds_read_b64_tr_b16 a[202:203], v24 offset:11264
ds_read_b64_tr_b16 a[204:205], v25 offset:10240
ds_read_b64_tr_b16 a[206:207], v25 offset:11264
v_mfma_f32_32x32x16_bf16 v[48:63], a[220:223], a[44:47], v[48:63]
buffer_load_dwordx4 a[76:79], v26, s[76:79], s68 offen offset:3072 sc1
v_lshlrev_b32 v210, 16, v169
s_waitcnt vmcnt(8) lgkmcnt(0)
v_mfma_f32_32x32x16_bf16 v[32:47], a[192:195], a[48:51], v[32:47]
ds_read_b64_tr_b16 a[208:209], v24 offset:12288
ds_read_b64_tr_b16 a[210:211], v24 offset:13312
ds_read_b64_tr_b16 a[212:213], v25 offset:12288
v_and_b32 v211, 0xffff0000, v169
s_add_u32 m0, s41, 32768
v_mfma_f32_32x32x16_bf16 v[48:63], a[196:199], a[48:51], v[48:63]
buffer_load_dwordx4 v8, s[16:19], s59 offen lds
ds_read_b64_tr_b16 a[214:215], v25 offset:13312
ds_read_b64_tr_b16 a[216:217], v24 offset:14336
ds_read_b64_tr_b16 a[218:219], v24 offset:15360
v_mfma_f32_32x32x16_bf16 v[32:47], a[200:203], a[52:55], v[32:47]
buffer_load_dwordx4 a[80:83], v26, s[76:79], s69 offen offset:0 sc1
ds_read_b64_tr_b16 a[220:221], v25 offset:14336
ds_read_b64_tr_b16 a[222:223], v25 offset:15360
v_mfma_f32_32x32x16_bf16 v[48:63], a[204:207], a[52:55], v[48:63]
buffer_load_dwordx4 a[84:87], v26, s[76:79], s69 offen offset:1024 sc1
s_waitcnt vmcnt(9) lgkmcnt(0)
v_mfma_f32_32x32x16_bf16 v[32:47], a[208:211], a[56:59], v[32:47]
ds_read_b64_tr_b16 a[192:193], v24 offset:20480
ds_read_b64_tr_b16 a[194:195], v24 offset:21504
ds_read_b64_tr_b16 a[196:197], v25 offset:20480
v_lshlrev_b32 v212, 16, v170
s_add_u32 m0, s41, 36864
v_mfma_f32_32x32x16_bf16 v[48:63], a[212:215], a[56:59], v[48:63]
buffer_load_dwordx4 v10, s[16:19], s59 offen lds
ds_read_b64_tr_b16 a[198:199], v25 offset:21504
ds_read_b64_tr_b16 a[200:201], v24 offset:22528
ds_read_b64_tr_b16 a[202:203], v24 offset:23552
v_and_b32 v213, 0xffff0000, v170
v_mfma_f32_32x32x16_bf16 v[32:47], a[216:219], a[60:63], v[32:47]
buffer_load_dwordx4 a[88:91], v26, s[76:79], s69 offen offset:2048 sc1
ds_read_b64_tr_b16 a[204:205], v25 offset:22528
ds_read_b64_tr_b16 a[206:207], v25 offset:23552
v_mfma_f32_32x32x16_bf16 v[48:63], a[220:223], a[60:63], v[48:63]
buffer_load_dwordx4 a[92:95], v26, s[76:79], s69 offen offset:3072 sc1
s_waitcnt vmcnt(10) lgkmcnt(0)
v_mfma_f32_32x32x16_bf16 v[32:47], a[192:195], a[64:67], v[32:47]
ds_read_b64_tr_b16 a[208:209], v24 offset:24576
ds_read_b64_tr_b16 a[210:211], v24 offset:25600
ds_read_b64_tr_b16 a[212:213], v25 offset:24576
s_waitcnt vmcnt(8)
L_m6_sp11:
v_cmp_eq_u64 vcc, s[48:49], v[0:1]
s_nop 1
s_and_b32 s44, vcc_lo, 63
s_cmp_eq_u32 s44, 63
s_cbranch_scc0 L_m6_ok11x
L_m6_ok11:
s_add_u32 m0, s41, 40960
v_mfma_f32_32x32x16_bf16 v[48:63], a[196:199], a[64:67], v[48:63]
buffer_load_dwordx4 v8, s[16:19], s60 offen lds
ds_read_b64_tr_b16 a[214:215], v25 offset:25600
ds_read_b64_tr_b16 a[216:217], v24 offset:26624
ds_read_b64_tr_b16 a[218:219], v24 offset:27648
v_mfma_f32_32x32x16_bf16 v[32:47], a[200:203], a[68:71], v[32:47]
buffer_load_dwordx4 a[96:99], v26, s[76:79], s70 offen offset:0 sc1
ds_read_b64_tr_b16 a[220:221], v25 offset:26624
ds_read_b64_tr_b16 a[222:223], v25 offset:27648
v_mfma_f32_32x32x16_bf16 v[48:63], a[204:207], a[68:71], v[48:63]
buffer_load_dwordx4 a[100:103], v26, s[76:79], s70 offen offset:1024 sc1
v_lshlrev_b32 v214, 16, v171
s_waitcnt vmcnt(9) lgkmcnt(0)
v_mfma_f32_32x32x16_bf16 v[32:47], a[208:211], a[72:75], v[32:47]
ds_read_b64_tr_b16 a[192:193], v20 offset:8192
ds_read_b64_tr_b16 a[194:195], v20 offset:9216
ds_read_b64_tr_b16 a[196:197], v21 offset:8192
v_and_b32 v215, 0xffff0000, v171
s_add_u32 m0, s41, 45056
v_mfma_f32_32x32x16_bf16 v[48:63], a[212:215], a[72:75], v[48:63]
buffer_load_dwordx4 v10, s[16:19], s60 offen lds
ds_read_b64_tr_b16 a[198:199], v21 offset:9216
ds_read_b64_tr_b16 a[200:201], v20 offset:10240
ds_read_b64_tr_b16 a[202:203], v20 offset:11264
v_mfma_f32_32x32x16_bf16 v[32:47], a[216:219], a[76:79], v[32:47]
buffer_load_dwordx4 a[104:107], v26, s[76:79], s70 offen offset:2048 sc1
ds_read_b64_tr_b16 a[204:205], v21 offset:10240
ds_read_b64_tr_b16 a[206:207], v21 offset:11264
v_mfma_f32_32x32x16_bf16 v[48:63], a[220:223], a[76:79], v[48:63]
buffer_load_dwordx4 a[108:111], v26, s[76:79], s70 offen offset:3072 sc1
s_waitcnt vmcnt(9) lgkmcnt(0)
v_mfma_f32_32x32x16_bf16 v[32:47], a[192:195], a[80:83], v[32:47]
ds_read_b64_tr_b16 a[208:209], v20 offset:12288
ds_read_b64_tr_b16 a[210:211], v20 offset:13312
ds_read_b64_tr_b16 a[212:213], v21 offset:12288
v_lshlrev_b32 v216, 16, v172
s_add_u32 m0, s41, 49152
v_mfma_f32_32x32x16_bf16 v[48:63], a[196:199], a[80:83], v[48:63]
buffer_load_dwordx4 v8, s[16:19], s61 offen lds
ds_read_b64_tr_b16 a[214:215], v21 offset:13312
ds_read_b64_tr_b16 a[216:217], v20 offset:14336
ds_read_b64_tr_b16 a[218:219], v20 offset:15360
v_and_b32 v217, 0xffff0000, v172
v_mfma_f32_32x32x16_bf16 v[32:47], a[200:203], a[84:87], v[32:47]
buffer_load_dwordx4 a[112:115], v26, s[76:79], s71 offen offset:0 sc1
ds_read_b64_tr_b16 a[220:221], v21 offset:14336
ds_read_b64_tr_b16 a[222:223], v21 offset:15360
v_mfma_f32_32x32x16_bf16 v[48:63], a[204:207], a[84:87], v[48:63]
buffer_load_dwordx4 a[116:119], v26, s[76:79], s71 offen offset:1024 sc1
s_waitcnt vmcnt(9) lgkmcnt(0)
v_mfma_f32_32x32x16_bf16 v[32:47], a[208:211], a[88:91], v[32:47]
s_barrier
ds_read_b64_tr_b16 a[192:193], v20 offset:16384
ds_read_b64_tr_b16 a[194:195], v20 offset:17408
s_add_u32 m0, s41, 53248
v_mfma_f32_32x32x16_bf16 v[48:63], a[212:215], a[88:91], v[48:63]
buffer_load_dwordx4 v10, s[16:19], s61 offen lds
ds_read_b64_tr_b16 a[196:197], v21 offset:16384
ds_read_b64_tr_b16 a[198:199], v21 offset:17408
ds_read_b64_tr_b16 a[200:201], v20 offset:18432
v_mfma_f32_32x32x16_bf16 v[32:47], a[216:219], a[92:95], v[32:47]
buffer_load_dwordx4 a[120:123], v26, s[76:79], s71 offen offset:2048 sc1
ds_read_b64_tr_b16 a[202:203], v20 offset:19456
ds_read_b64_tr_b16 a[204:205], v21 offset:18432
ds_read_b64_tr_b16 a[206:207], v21 offset:19456
v_mfma_f32_32x32x16_bf16 v[48:63], a[220:223], a[92:95], v[48:63]
buffer_load_dwordx4 a[124:127], v26, s[76:79], s71 offen offset:3072 sc1
s_waitcnt vmcnt(9) lgkmcnt(0)
v_mfma_f32_32x32x16_bf16 v[32:47], a[192:195], a[96:99], v[32:47]
ds_read_b64_tr_b16 a[208:209], v20 offset:20480
ds_read_b64_tr_b16 a[210:211], v20 offset:21504
ds_read_b64_tr_b16 a[212:213], v21 offset:20480
v_lshlrev_b32 v218, 16, v173
s_add_u32 m0, s41, 57344
v_mfma_f32_32x32x16_bf16 v[48:63], a[196:199], a[96:99], v[48:63]
buffer_load_dwordx4 v8, s[16:19], s62 offen lds
ds_read_b64_tr_b16 a[214:215], v21 offset:21504
ds_read_b64_tr_b16 a[216:217], v20 offset:22528
ds_read_b64_tr_b16 a[218:219], v20 offset:23552
v_and_b32 v219, 0xffff0000, v173
v_mfma_f32_32x32x16_bf16 v[32:47], a[200:203], a[100:103], v[32:47]
buffer_load_dwordx4 a[128:131], v26, s[76:79], s72 offen offset:0 sc1
ds_read_b64_tr_b16 a[220:221], v21 offset:22528
ds_read_b64_tr_b16 a[222:223], v21 offset:23552
v_mfma_f32_32x32x16_bf16 v[48:63], a[204:207], a[100:103], v[48:63]
buffer_load_dwordx4 a[132:135], v26, s[76:79], s72 offen offset:1024 sc1
s_waitcnt vmcnt(9) lgkmcnt(0)
v_mfma_f32_32x32x16_bf16 v[32:47], a[208:211], a[104:107], v[32:47]
ds_read_b64_tr_b16 a[192:193], v20 offset:24576
ds_read_b64_tr_b16 a[194:195], v20 offset:25600
ds_read_b64_tr_b16 a[196:197], v21 offset:24576
v_lshlrev_b32 v220, 16, v174
s_add_u32 m0, s41, 61440
v_mfma_f32_32x32x16_bf16 v[48:63], a[212:215], a[104:107], v[48:63]
buffer_load_dwordx4 v10, s[16:19], s62 offen lds
ds_read_b64_tr_b16 a[198:199], v21 offset:25600
ds_read_b64_tr_b16 a[200:201], v20 offset:26624
ds_read_b64_tr_b16 a[202:203], v20 offset:27648
v_mfma_f32_32x32x16_bf16 v[32:47], a[216:219], a[108:111], v[32:47]
buffer_load_dwordx4 a[136:139], v26, s[76:79], s72 offen offset:2048 sc1
ds_read_b64_tr_b16 a[204:205], v21 offset:26624
ds_read_b64_tr_b16 a[206:207], v21 offset:27648
v_mfma_f32_32x32x16_bf16 v[48:63], a[220:223], a[108:111], v[48:63]
buffer_load_dwordx4 a[140:143], v26, s[76:79], s72 offen offset:3072 sc1
s_waitcnt vmcnt(9) lgkmcnt(0)
v_mfma_f32_32x32x16_bf16 v[32:47], a[192:195], a[112:115], v[32:47]
ds_read_b64_tr_b16 a[208:209], v20 offset:28672
ds_read_b64_tr_b16 a[210:211], v20 offset:29696
ds_read_b64_tr_b16 a[212:213], v21 offset:28672
v_and_b32 v221, 0xffff0000, v174
v_lshlrev_b32 v222, 16, v175
v_mfma_f32_32x32x16_bf16 v[48:63], a[196:199], a[112:115], v[48:63]
buffer_load_dwordx4 a[144:147], v26, s[76:79], s73 offen offset:0 sc1
ds_read_b64_tr_b16 a[214:215], v21 offset:29696
ds_read_b64_tr_b16 a[216:217], v20 offset:30720
ds_read_b64_tr_b16 a[218:219], v20 offset:31744
v_mfma_f32_32x32x16_bf16 v[32:47], a[200:203], a[116:119], v[32:47]
buffer_load_dwordx4 a[148:151], v26, s[76:79], s73 offen offset:1024 sc1
ds_read_b64_tr_b16 a[220:221], v21 offset:30720
ds_read_b64_tr_b16 a[222:223], v21 offset:31744
v_mfma_f32_32x32x16_bf16 v[48:63], a[204:207], a[116:119], v[48:63]
buffer_load_dwordx4 a[152:155], v26, s[76:79], s73 offen offset:2048 sc1
s_waitcnt vmcnt(9) lgkmcnt(0)
v_mfma_f32_32x32x16_bf16 v[32:47], a[208:211], a[120:123], v[32:47]
ds_read_b64_tr_b16 a[192:193], v20 offset:32768
ds_read_b64_tr_b16 a[194:195], v20 offset:33792
ds_read_b64_tr_b16 a[196:197], v21 offset:32768
v_and_b32 v223, 0xffff0000, v175
v_mfma_f32_32x32x16_bf16 v[48:63], a[212:215], a[120:123], v[48:63]
buffer_load_dwordx4 a[156:159], v26, s[76:79], s73 offen offset:3072 sc1
ds_read_b64_tr_b16 a[198:199], v21 offset:33792
ds_read_b64_tr_b16 a[200:201], v20 offset:34816
ds_read_b64_tr_b16 a[202:203], v20 offset:35840
v_mfma_f32_32x32x16_bf16 v[32:47], a[216:219], a[124:127], v[32:47]
buffer_load_dwordx4 a[160:163], v26, s[76:79], s74 offen offset:0 sc1
ds_read_b64_tr_b16 a[204:205], v21 offset:34816
ds_read_b64_tr_b16 a[206:207], v21 offset:35840
v_mfma_f32_32x32x16_bf16 v[48:63], a[220:223], a[124:127], v[48:63]
buffer_load_dwordx4 a[164:167], v26, s[76:79], s74 offen offset:1024 sc1
s_waitcnt vmcnt(9) lgkmcnt(0)
v_mfma_f32_32x32x16_bf16 v[32:47], a[192:195], a[128:131], v[32:47]
ds_read_b64_tr_b16 a[208:209], v20 offset:36864
ds_read_b64_tr_b16 a[210:211], v20 offset:37888
ds_read_b64_tr_b16 a[212:213], v21 offset:36864
v_mfma_f32_32x32x16_bf16 v[48:63], a[196:199], a[128:131], v[48:63]
buffer_load_dwordx4 a[168:171], v26, s[76:79], s74 offen offset:2048 sc1
ds_read_b64_tr_b16 a[214:215], v21 offset:37888
ds_read_b64_tr_b16 a[216:217], v20 offset:38912
ds_read_b64_tr_b16 a[218:219], v20 offset:39936
v_mfma_f32_32x32x16_bf16 v[32:47], a[200:203], a[132:135], v[32:47]
buffer_load_dwordx4 a[172:175], v26, s[76:79], s74 offen offset:3072 sc1
ds_read_b64_tr_b16 a[220:221], v21 offset:38912
ds_read_b64_tr_b16 a[222:223], v21 offset:39936
v_mfma_f32_32x32x16_bf16 v[48:63], a[204:207], a[132:135], v[48:63]
buffer_load_dwordx4 a[176:179], v26, s[76:79], s75 offen offset:0 sc1
s_waitcnt vmcnt(9) lgkmcnt(0)
v_mfma_f32_32x32x16_bf16 v[32:47], a[208:211], a[136:139], v[32:47]
s_barrier
ds_read_b64_tr_b16 a[192:193], v20 offset:40960
ds_read_b64_tr_b16 a[194:195], v20 offset:41984
v_mfma_f32_32x32x16_bf16 v[48:63], a[212:215], a[136:139], v[48:63]
buffer_load_dwordx4 a[180:183], v26, s[76:79], s75 offen offset:1024 sc1
ds_read_b64_tr_b16 a[196:197], v21 offset:40960
ds_read_b64_tr_b16 a[198:199], v21 offset:41984
ds_read_b64_tr_b16 a[200:201], v20 offset:43008
v_mfma_f32_32x32x16_bf16 v[32:47], a[216:219], a[140:143], v[32:47]
buffer_load_dwordx4 a[184:187], v26, s[76:79], s75 offen offset:2048 sc1
ds_read_b64_tr_b16 a[202:203], v20 offset:44032
ds_read_b64_tr_b16 a[204:205], v21 offset:43008
ds_read_b64_tr_b16 a[206:207], v21 offset:44032
v_mfma_f32_32x32x16_bf16 v[48:63], a[220:223], a[140:143], v[48:63]
buffer_load_dwordx4 a[188:191], v26, s[76:79], s75 offen offset:3072 sc1
s_waitcnt vmcnt(10) lgkmcnt(0)
v_mfma_f32_32x32x16_bf16 v[32:47], a[192:195], a[144:147], v[32:47]
ds_read_b64_tr_b16 a[208:209], v20 offset:45056
ds_read_b64_tr_b16 a[210:211], v20 offset:46080
ds_read_b64_tr_b16 a[212:213], v21 offset:45056
v_mfma_f32_32x32x16_bf16 v[48:63], a[196:199], a[144:147], v[48:63]
ds_read_b64_tr_b16 a[214:215], v21 offset:46080
ds_read_b64_tr_b16 a[216:217], v20 offset:47104
ds_read_b64_tr_b16 a[218:219], v20 offset:48128
v_mfma_f32_32x32x16_bf16 v[32:47], a[200:203], a[148:151], v[32:47]
ds_read_b64_tr_b16 a[220:221], v21 offset:47104
ds_read_b64_tr_b16 a[222:223], v21 offset:48128
v_mfma_f32_32x32x16_bf16 v[48:63], a[204:207], a[148:151], v[48:63]
s_waitcnt vmcnt(8) lgkmcnt(0)
v_mfma_f32_32x32x16_bf16 v[32:47], a[208:211], a[152:155], v[32:47]
ds_read_b64_tr_b16 a[192:193], v20 offset:49152
ds_read_b64_tr_b16 a[194:195], v20 offset:50176
ds_read_b64_tr_b16 a[196:197], v21 offset:49152
v_mfma_f32_32x32x16_bf16 v[48:63], a[212:215], a[152:155], v[48:63]
ds_read_b64_tr_b16 a[198:199], v21 offset:50176
ds_read_b64_tr_b16 a[200:201], v20 offset:51200
ds_read_b64_tr_b16 a[202:203], v20 offset:52224
v_mfma_f32_32x32x16_bf16 v[32:47], a[216:219], a[156:159], v[32:47]
ds_read_b64_tr_b16 a[204:205], v21 offset:51200
ds_read_b64_tr_b16 a[206:207], v21 offset:52224
v_mfma_f32_32x32x16_bf16 v[48:63], a[220:223], a[156:159], v[48:63]
s_waitcnt vmcnt(6) lgkmcnt(0)
v_mfma_f32_32x32x16_bf16 v[32:47], a[192:195], a[160:163], v[32:47]
ds_read_b64_tr_b16 a[208:209], v20 offset:53248
ds_read_b64_tr_b16 a[210:211], v20 offset:54272
ds_read_b64_tr_b16 a[212:213], v21 offset:53248
v_mfma_f32_32x32x16_bf16 v[48:63], a[196:199], a[160:163], v[48:63]
ds_read_b64_tr_b16 a[214:215], v21 offset:54272
ds_read_b64_tr_b16 a[216:217], v20 offset:55296
ds_read_b64_tr_b16 a[218:219], v20 offset:56320
v_mfma_f32_32x32x16_bf16 v[32:47], a[200:203], a[164:167], v[32:47]
ds_read_b64_tr_b16 a[220:221], v21 offset:55296
ds_read_b64_tr_b16 a[222:223], v21 offset:56320
v_mfma_f32_32x32x16_bf16 v[48:63], a[204:207], a[164:167], v[48:63]
s_waitcnt vmcnt(4) lgkmcnt(0)
v_mfma_f32_32x32x16_bf16 v[32:47], a[208:211], a[168:171], v[32:47]
ds_read_b64_tr_b16 a[192:193], v20 offset:57344
ds_read_b64_tr_b16 a[194:195], v20 offset:58368
ds_read_b64_tr_b16 a[196:197], v21 offset:57344
v_mfma_f32_32x32x16_bf16 v[48:63], a[212:215], a[168:171], v[48:63]
ds_read_b64_tr_b16 a[198:199], v21 offset:58368
ds_read_b64_tr_b16 a[200:201], v20 offset:59392
ds_read_b64_tr_b16 a[202:203], v20 offset:60416
v_mfma_f32_32x32x16_bf16 v[32:47], a[216:219], a[172:175], v[32:47]
ds_read_b64_tr_b16 a[204:205], v21 offset:59392
ds_read_b64_tr_b16 a[206:207], v21 offset:60416
v_mfma_f32_32x32x16_bf16 v[48:63], a[220:223], a[172:175], v[48:63]
s_waitcnt vmcnt(2) lgkmcnt(0)
v_mfma_f32_32x32x16_bf16 v[32:47], a[192:195], a[176:179], v[32:47]
ds_read_b64_tr_b16 a[208:209], v20 offset:61440
ds_read_b64_tr_b16 a[210:211], v20 offset:62464
ds_read_b64_tr_b16 a[212:213], v21 offset:61440
v_mfma_f32_32x32x16_bf16 v[48:63], a[196:199], a[176:179], v[48:63]
ds_read_b64_tr_b16 a[214:215], v21 offset:62464
ds_read_b64_tr_b16 a[216:217], v20 offset:63488
ds_read_b64_tr_b16 a[218:219], v20 offset:64512
v_mfma_f32_32x32x16_bf16 v[32:47], a[200:203], a[180:183], v[32:47]
ds_read_b64_tr_b16 a[220:221], v21 offset:63488
ds_read_b64_tr_b16 a[222:223], v21 offset:64512
v_mfma_f32_32x32x16_bf16 v[48:63], a[204:207], a[180:183], v[48:63]
s_waitcnt vmcnt(0) lgkmcnt(0)
v_mfma_f32_32x32x16_bf16 v[32:47], a[208:211], a[184:187], v[32:47]
v_mfma_f32_32x32x16_bf16 v[48:63], a[212:215], a[184:187], v[48:63]
v_mfma_f32_32x32x16_bf16 v[32:47], a[216:219], a[188:191], v[32:47]
v_mfma_f32_32x32x16_bf16 v[48:63], a[220:223], a[188:191], v[48:63]
s_nop 10
v_fma_f32 v32, v96, v32, v192
v_fma_f32 v33, v97, v33, v193
v_cvt_pk_bf16_f32 v160, v32, v33
v_fma_f32 v34, v98, v34, v194
v_fma_f32 v35, v99, v35, v195
v_cvt_pk_bf16_f32 v161, v34, v35
v_fma_f32 v36, v100, v36, v196
v_fma_f32 v37, v101, v37, v197
v_cvt_pk_bf16_f32 v162, v36, v37
v_fma_f32 v38, v102, v38, v198
v_fma_f32 v39, v103, v39, v199
v_cvt_pk_bf16_f32 v163, v38, v39
v_fma_f32 v40, v104, v40, v200
v_fma_f32 v41, v105, v41, v201
v_cvt_pk_bf16_f32 v164, v40, v41
v_fma_f32 v42, v106, v42, v202
v_fma_f32 v43, v107, v43, v203
v_cvt_pk_bf16_f32 v165, v42, v43
v_fma_f32 v44, v108, v44, v204
v_fma_f32 v45, v109, v45, v205
v_cvt_pk_bf16_f32 v166, v44, v45
v_fma_f32 v46, v110, v46, v206
v_fma_f32 v47, v111, v47, v207
v_cvt_pk_bf16_f32 v167, v46, v47
v_fma_f32 v48, v112, v48, v208
v_fma_f32 v49, v113, v49, v209
v_cvt_pk_bf16_f32 v168, v48, v49
v_fma_f32 v50, v114, v50, v210
v_fma_f32 v51, v115, v51, v211
v_cvt_pk_bf16_f32 v169, v50, v51
v_fma_f32 v52, v116, v52, v212
v_fma_f32 v53, v117, v53, v213
v_cvt_pk_bf16_f32 v170, v52, v53
v_fma_f32 v54, v118, v54, v214
v_fma_f32 v55, v119, v55, v215
v_cvt_pk_bf16_f32 v171, v54, v55
v_fma_f32 v56, v120, v56, v216
v_fma_f32 v57, v121, v57, v217
v_cvt_pk_bf16_f32 v172, v56, v57
v_fma_f32 v58, v122, v58, v218
v_fma_f32 v59, v123, v59, v219
v_cvt_pk_bf16_f32 v173, v58, v59
v_fma_f32 v60, v124, v60, v220
v_fma_f32 v61, v125, v61, v221
v_cvt_pk_bf16_f32 v174, v60, v61
v_fma_f32 v62, v126, v62, v222
v_fma_f32 v63, v127, v63, v223
v_cvt_pk_bf16_f32 v175, v62, v63
v_subrev_u32 v16, s35, v26
v_add_u32 v16, s47, v16
v_xor_b32 v2, 0, v27
v_lshl_add_u32 v2, v2, 4, v28
ds_write_b64 v2, v[160:161]
v_xor_b32 v2, 1, v27
v_lshl_add_u32 v2, v2, 4, v28
ds_write_b64 v2, v[162:163]
v_xor_b32 v2, 2, v27
v_lshl_add_u32 v2, v2, 4, v28
ds_write_b64 v2, v[164:165]
v_xor_b32 v2, 3, v27
v_lshl_add_u32 v2, v2, 4, v28
ds_write_b64 v2, v[166:167]
v_xor_b32 v2, 4, v27
v_lshl_add_u32 v2, v2, 4, v28
ds_write_b64 v2, v[168:169]
v_xor_b32 v2, 5, v27
v_lshl_add_u32 v2, v2, 4, v28
ds_write_b64 v2, v[170:171]
v_xor_b32 v2, 6, v27
v_lshl_add_u32 v2, v2, 4, v28
ds_write_b64 v2, v[172:173]
v_xor_b32 v2, 7, v27
v_lshl_add_u32 v2, v2, 4, v28
ds_write_b64 v2, v[174:175]
s_waitcnt lgkmcnt(0)
ds_read_b128 v[224:227], v16 offset:0
ds_read_b128 v[228:231], v16 offset:1024
ds_read_b128 v[232:235], v16 offset:2048
ds_read_b128 v[236:239], v16 offset:3072
s_waitcnt lgkmcnt(3)
s_mov_b32 s43, s34
buffer_store_dwordx4 v[224:227], v12, s[28:31], s43 offen offset:0 sc1
s_waitcnt lgkmcnt(2)
buffer_store_dwordx4 v[228:231], v13, s[28:31], s43 offen offset:1024 sc1
s_waitcnt lgkmcnt(1)
buffer_store_dwordx4 v[232:235], v14, s[28:31], s43 offen offset:2048 sc1
s_waitcnt lgkmcnt(0)
buffer_store_dwordx4 v[236:239], v15, s[28:31], s43 offen offset:3072 sc1
s_endpgm
L_m6_ok99x:
s_sleep 1
buffer_load_dwordx2 v[0:1], v30, s[24:27], s45 offen sc1
s_sub_u32 s46, s46, 1
s_waitcnt vmcnt(0)
s_cbranch_scc0 L_m6_sp99
s_branch L_m6_ok99
L_m6_fl0x:
buffer_store_dwordx2 v[6:7], v31, s[24:27], s44 offen sc1
s_branch L_m6_fl0j
L_m6_ok00x:
s_sleep 1
buffer_load_dwordx2 v[0:1], v30, s[24:27], s45 offen sc1
s_sub_u32 s46, s46, 1
s_waitcnt vmcnt(0)
s_cbranch_scc0 L_m6_sp00
s_branch L_m6_ok00
L_m6_ok01x:
s_sleep 1
buffer_load_dwordx2 v[0:1], v30, s[24:27], s45 offen sc1
s_sub_u32 s46, s46, 1
s_waitcnt vmcnt(0)
s_cbranch_scc0 L_m6_sp01
s_branch L_m6_ok01
L_m6_fl5x:
buffer_store_dwordx2 v[6:7], v31, s[24:27], s44 offen sc1
s_branch L_m6_fl5j
L_m6_ok88x:
s_sleep 1
buffer_load_dwordx2 v[0:1], v30, s[24:27], s45 offen sc1
s_sub_u32 s46, s46, 1
s_waitcnt vmcnt(0)
s_cbranch_scc0 L_m6_sp88
s_branch L_m6_ok88
L_m6_st100x:
buffer_store_dwordx4 v[160:163], v26, s[24:27], s43 offen offset:0 sc1
s_branch L_m6_st100j
L_m6_st101x:
buffer_store_dwordx4 v[164:167], v26, s[24:27], s43 offen offset:1024 sc1
s_branch L_m6_st101j
L_m6_st102x:
buffer_store_dwordx4 v[168:171], v26, s[24:27], s43 offen offset:2048 sc1
s_branch L_m6_st102j
L_m6_st103x:
buffer_store_dwordx4 v[172:175], v26, s[24:27], s43 offen offset:3072 sc1
s_branch L_m6_st103j
L_m6_fl2x:
buffer_store_dwordx2 v[6:7], v31, s[24:27], s44 offen sc1
v_subrev_u32 v2, s35, v26
v_and_b32 v2, 0x1f0, v2
v_lshl_add_u32 v2, v2, 3, s35
s_add_u32 s40, s63, 25165824
buffer_load_dword a224, v2, s[24:27], s40 offen sc1
s_branch L_m6_fl2j
L_m6_ok10x:
s_sleep 1
buffer_load_dwordx2 v[0:1], v30, s[24:27], s45 offen sc1
s_sub_u32 s46, s46, 1
s_waitcnt vmcnt(0)
s_cbranch_scc0 L_m6_sp10
s_branch L_m6_ok10
L_m6_ok11x:
s_sleep 1
buffer_load_dwordx2 v[0:1], v30, s[24:27], s45 offen sc1
s_sub_u32 s46, s46, 1
s_waitcnt vmcnt(0)
s_cbranch_scc0 L_m6_sp11
s_branch L_m6_ok11

L_helper:
s_waitcnt lgkmcnt(0)
s_mov_b32 s20, s4
s_mov_b32 s21, s5
s_mov_b32 s16, s6
s_mov_b32 s17, s7
s_mov_b32 s24, s14
s_mov_b32 s25, s15
s_mov_b32 s26, 33554432
s_mov_b32 s27, 0x20000
s_getpc_b64 s[40:41]
L_pc:
s_sub_u32 s40, s40, L_pc-standalone__cross_network_dcn__recsys_kernel
s_subb_u32 s41, s41, 0
s_lshl_b32 s42, s39, 2
s_add_u32 s42, s42, s38
s_lshl_b32 s42, s42, 13
s_cmp_ge_u32 s42, L_pc-standalone__cross_network_dcn__recsys_kernel
s_cbranch_scc1 L_cpf_done
v_lshl_add_u32 v3, v1, 7, s42
v_min_u32 v3, L_pc-standalone__cross_network_dcn__recsys_kernel, v3
global_load_dword v9, v3, s[40:41]
L_cpf_done:
v_mul_u32_u24 v2, 1664, v1
s_mov_b32 s40, 0x541032
s_cmp_eq_u32 s39, 1
s_cselect_b32 s40, 0x543210, s40
s_cmp_eq_u32 s39, 2
s_cselect_b32 s40, 0x543210, s40
s_cmp_eq_u32 s39, 3
s_cselect_b32 s40, 0x543021, s40
s_bfe_u32 s42, s40, 0x40000
s_add_u32 s42, s42, s93
s_sub_u32 s43, s42, 6
s_min_u32 s42, s42, s43
s_lshl_b32 s42, s42, 8
s_add_u32 s80, s42, 128
s_bfe_u32 s42, s40, 0x40004
s_add_u32 s42, s42, s93
s_sub_u32 s43, s42, 6
s_min_u32 s42, s42, s43
s_lshl_b32 s42, s42, 8
s_add_u32 s81, s42, 128
s_bfe_u32 s42, s40, 0x40008
s_add_u32 s42, s42, s93
s_sub_u32 s43, s42, 6
s_min_u32 s42, s42, s43
s_lshl_b32 s42, s42, 8
s_add_u32 s82, s42, 128
s_bfe_u32 s42, s40, 0x4000c
s_add_u32 s42, s42, s93
s_sub_u32 s43, s42, 6
s_min_u32 s42, s42, s43
s_lshl_b32 s42, s42, 8
s_add_u32 s83, s42, 128
s_bfe_u32 s42, s40, 0x40010
s_add_u32 s42, s42, s93
s_sub_u32 s43, s42, 6
s_min_u32 s42, s42, s43
s_lshl_b32 s42, s42, 8
s_add_u32 s84, s42, 128
s_bfe_u32 s42, s40, 0x40014
s_add_u32 s42, s42, s93
s_sub_u32 s43, s42, 6
s_min_u32 s42, s42, s43
s_lshl_b32 s42, s42, 8
s_add_u32 s85, s42, 128
s_and_b32 s44, s38, 1
s_lshl_b32 s45, s37, 1
s_add_u32 s44, s44, s45
s_mul_i32 s44, s44, 106496
s_cmp_ge_u32 s38, 2
s_cselect_b32 s45, s81, s80
s_add_u32 s40, s44, s45
buffer_load_dword v8, v2, s[20:23], s40 offen
s_cmp_ge_u32 s38, 2
s_cselect_b32 s45, s83, s82
s_add_u32 s40, s44, s45
buffer_load_dword v8, v2, s[20:23], s40 offen
s_cmp_ge_u32 s38, 2
s_cselect_b32 s45, s85, s84
s_add_u32 s40, s44, s45
buffer_load_dword v8, v2, s[20:23], s40 offen
s_lshl_b32 s42, s39, 2
s_add_u32 s42, s42, s38
s_cmp_ge_u32 s42, 12
s_cbranch_scc1 L_hd_done
s_or_b32 s43, s42, 1
s_mul_i32 s43, s43, 106496
s_lshl_b32 s42, s42, 7
s_add_u32 s40, s43, s42
buffer_load_dword v8, v2, s[16:19], s40 offen
L_hd_done:
s_lshl_b32 s50, s39, 2
s_add_u32 s50, s50, s38
s_add_u32 s50, s50, 169
L_hp2:
s_cmp_ge_u32 s50, 507
s_cbranch_scc1 L_hp2_done
s_mul_i32 s51, s50, 5042
s_lshr_b32 s51, s51, 16
s_mul_i32 s52, s51, 13
s_sub_u32 s52, s50, s52
s_mul_i32 s53, s51, 5042
s_lshr_b32 s53, s53, 16
s_mul_i32 s54, s53, 13
s_sub_u32 s54, s51, s54
s_lshr_b32 s55, s52, 1
s_sub_u32 s56, s54, 1
s_max_i32 s56, s56, 0
s_add_u32 s56, s56, s55
s_cmp_ge_u32 s56, 7
s_cselect_b32 s57, 7, 0
s_sub_u32 s56, s56, s57
s_lshl_b32 s56, s56, 1
s_sub_u32 s57, s54, 7
s_max_i32 s57, s57, 0
s_cmp_eq_u32 s55, 6
s_cselect_b32 s58, 0, s55
s_add_u32 s57, s57, s58
s_cmp_ge_u32 s57, 6
s_cselect_b32 s58, 6, 0
s_sub_u32 s57, s57, s58
s_lshl_b32 s57, s57, 1
s_add_u32 s57, s57, 1
s_cmp_eq_u32 s54, 1
s_cselect_b32 s56, s57, s56
s_cmp_ge_u32 s54, 8
s_cselect_b32 s56, s57, s56
s_mul_i32 s56, s56, 106496
s_mul_i32 s53, s53, 1384448
s_lshl_b32 s52, s52, 7
s_add_u32 s40, s56, s53
s_add_u32 s40, s40, s52
buffer_load_dword v8, v2, s[16:19], s40 offen
s_waitcnt vmcnt(1)
s_add_u32 s50, s50, 16
s_branch L_hp2
L_hp2_done:
s_waitcnt vmcnt(0)
s_endpgm

L_end:
s_endpgm
.section .rodata,"a"
.p2align 6
.amdhsa_kernel standalone__cross_network_dcn__recsys_kernel
  .amdhsa_next_free_vgpr 488
  .amdhsa_next_free_sgpr 102
  .amdhsa_accum_offset 256
  .amdhsa_group_segment_fixed_size 0
  .amdhsa_kernarg_size 48
  .amdhsa_user_sgpr_count 2
  .amdhsa_user_sgpr_kernarg_segment_ptr 1
  .amdhsa_system_sgpr_workgroup_id_x 1
  .amdhsa_float_denorm_mode_32 3
.end_amdhsa_kernel
```
